```python
import torch

def _softmax(x, axis=-1):
    return torch.softmax(x, dim=axis)
def _gelu(x):
    return torch.nn.functional.gelu(x, approximate="tanh")
def _silu(x):
    return torch.nn.functional.silu(x)
def _sigmoid(x):
    return torch.sigmoid(x)
def _layernorm(x, axis=-1, eps=1e-5):
    m = x.mean(dim=axis, keepdim=True)
    v = x.var(dim=axis, keepdim=True, unbiased=False)
    return (x - m) / torch.sqrt(v + eps)
def _scatter_add(tgt, idx, src, axis=0):
    return tgt.clone().index_add_(axis, idx, src)
def _segment_sum(src, seg, n):
    out = torch.zeros((n,) + src.shape[1:], dtype=src.dtype)
    return out.index_add_(0, seg, src)
def _pad(x, pw):
    flat = tuple(v for pair in reversed(pw) for v in pair)
    return torch.nn.functional.pad(x, flat)

kernel_name = 'gated_mix__sliding_local_dilated__dense_activation_gelu__prompt'

def setup_inputs():

    _w = (lambda a: (lambda t: t.to(torch.bfloat16) if t.is_floating_point() else t)(torch.as_tensor(a)))
    def _A_setup():
        B, S, D = 1, 2048, 640
        return {
            "x": _w((lambda *s: torch.randn(*s, dtype=torch.bfloat16) * 0.05)(B, S, D)),
            "wqkv": _w((lambda *s: torch.randn(*s, dtype=torch.bfloat16) * 0.8)(D, 3 * D)),
            "wo": _w((lambda *s: torch.randn(*s, dtype=torch.bfloat16) * 0.05)(D, D)),
        }
    _A_in = _A_setup()

    def _B_setup():
        B, S, D, F = 1, 2048, 640, 1536
        return {
            "x": _w((lambda *s: torch.randn(*s, dtype=torch.bfloat16) * 0.05)(B, S, D)),
            "w1": _w((lambda *s: torch.randn(*s, dtype=torch.bfloat16) * 12.8)(D, F) * (D ** -0.5)),
            "b1": _w((lambda *s: torch.randn(*s, dtype=torch.bfloat16) * 12.8)(F) * 0.01),
            "w2": _w((lambda *s: torch.randn(*s, dtype=torch.bfloat16) * 1.6)(F, D) * (F ** -0.5)),
            "b2": _w((lambda *s: torch.randn(*s, dtype=torch.bfloat16) * 12.8)(D) * 0.01),
        }
    _B_in = _B_setup()

    return {
        "A_x": _A_in["x"],
        "A_wqkv": _A_in["wqkv"],
        "A_wo": _A_in["wo"],
        "B_x": _B_in["x"],
        "B_w1": _B_in["w1"],
        "B_b1": _B_in["b1"],
        "B_w2": _B_in["w2"],
        "B_b2": _B_in["b2"],
        "gate_w": _w((lambda *s: torch.randn(*s, dtype=torch.bfloat16) * 0.05)(640) * 16.0),
    }

def reference(A_x, A_wqkv, A_wo, B_x, B_w1, B_b1, B_w2, B_b2, gate_w):
    def _A_ref(x, wqkv, wo):
        B, S, D = x.shape
        H = 32; Dh = D // H
        W, dil = 8, 2
        qkv = (lambda x, *d: x.permute(*d))((x @ wqkv).reshape(B, S, 3, H, Dh), 2, 0, 3, 1, 4)
        q, k, v = qkv[0], qkv[1], qkv[2]
        scale = Dh ** -0.5
        pos = torch.arange(S)
        off = torch.arange(W) * dil
        idx = pos[:, None] - off[None, :]
        mask = idx >= 0
        idx_c = torch.where(mask, idx, 0).reshape(-1)
        kg = k[:, :, idx_c, :].reshape(B, H, S, W, Dh)
        vg = v[:, :, idx_c, :].reshape(B, H, S, W, Dh)
        logits = torch.einsum("bhsd,bhswd->bhsw", q, kg) * scale
        logits = torch.where(mask[None, None, :, :], logits, -1e9)
        attn = _softmax(logits, axis=-1)
        o = torch.einsum("bhsw,bhswd->bhsd", attn, vg)
        return (lambda x, *d: x.permute(*d))(o, 0, 2, 1, 3).reshape(B, S, D) @ wo

    def _B_ref(x, w1, b1, w2, b2):
        h = torch.einsum("bsd,df->bsf", x, w1) + b1
        h = _gelu(h)
        return torch.einsum("bsf,fd->bsd", h, w2) + b2

    x = A_x
    g = _sigmoid((x * gate_w).sum(-1, keepdims=True))
    a = _A_ref(x, A_wqkv, A_wo)
    b = _B_ref(x, B_w1, B_b1, B_w2, B_b2)
    return g * a + (1 - g) * b
```

```asm
; @launch kernel=gm1_kernel grid=(256,1,1) block=(512,1,1) lds=147456
; @launch kernel=gm2_kernel grid=(256,1,1) block=(256,1,1) lds=81920
.amdgcn_target "amdgcn-amd-amdhsa--gfx950"
.text
.globl gm1_kernel
.p2align 8
.type gm1_kernel,@function
gm1_kernel:
  s_cmp_ge_u32 s2, 256
  s_cbranch_scc1 K1_EXIT
  s_load_dwordx4 s[4:7], s[0:1], 0
  s_load_dwordx8 s[12:19], s[0:1], 32
  s_load_dwordx2 s[8:9], s[0:1], 16
  s_load_dwordx2 s[20:21], s[0:1], 64
  s_load_dwordx2 s[22:23], s[0:1], 88
  v_and_b32 v1, 63, v0
  v_lshrrev_b32 v2, 6, v0
  s_and_b32 s50, s2, 7
  s_lshr_b32 s51, s2, 3
  v_readfirstlane_b32 s3, v2
  s_and_b32 s52, s51, 7
  s_lshr_b32 s53, s51, 3
  s_and_b32 s54, s50, 1
  s_lshl_b32 s54, s54, 3
  s_add_u32 s54, s54, s52
  s_and_b32 s55, s50, 6
  s_and_b32 s56, s53, 1
  s_add_u32 s55, s55, s56
  s_mul_i32 s56, s52, 5
  s_lshr_b32 s56, s56, 2
  s_lshl_b32 s57, s53, 2
  s_lshr_b32 s57, 0x7420, s57
  s_and_b32 s57, s57, 15
  s_add_u32 s42, s56, s57
  s_sub_u32 s56, s42, 10
  s_cmp_ge_u32 s42, 10
  s_cselect_b32 s42, s56, s42
  s_lshl_b32 s58, s54, 7
  s_and_b32 s59, s3, 3
  s_cmp_ge_u32 s53, 2
  s_cbranch_scc1 K1_MLP
  s_cmp_ge_u32 s3, 4
  s_cbranch_scc1 K1_QL
  v_lshrrev_b32 v2, 5, v1
  v_lshlrev_b32 v2, 4, v2
  v_bfe_u32 v5, v1, 2, 3
  v_add_u32 v2, v2, v5
  v_mul_u32_u24 v2, 480, v2
  v_and_b32 v5, 3, v1
  v_lshl_add_u32 v2, v5, 3, v2
  v_and_b32 v5, 15, v1
  v_lshrrev_b32 v6, 1, v5
  v_lshrrev_b32 v3, 4, v1
  v_xor_b32 v3, v3, v6
  v_lshlrev_b32 v3, 4, v3
  v_lshl_add_u32 v3, v5, 7, v3
  v_add_u32 v3, 30720, v3
  v_xor_b32 v4, 64, v3
  v_mov_b32 v8, 0
  v_mov_b32 v9, 0
  v_mov_b32 v10, 0
  v_mov_b32 v11, 0
  v_mov_b32 v12, 0
  v_mov_b32 v13, 0
  v_mov_b32 v14, 0
  v_mov_b32 v15, 0
  v_mov_b32 v16, 0
  v_mov_b32 v17, 0
  v_mov_b32 v18, 0
  v_mov_b32 v19, 0
  v_mov_b32 v20, 0
  v_mov_b32 v21, 0
  v_mov_b32 v22, 0
  v_mov_b32 v23, 0
  v_mov_b32 v24, 0
  v_mov_b32 v25, 0
  v_mov_b32 v26, 0
  v_mov_b32 v27, 0
  v_mov_b32 v28, 0
  v_mov_b32 v29, 0
  v_mov_b32 v30, 0
  v_mov_b32 v31, 0
  v_mov_b32 v32, 0
  v_mov_b32 v33, 0
  v_mov_b32 v34, 0
  v_mov_b32 v35, 0
  v_mov_b32 v36, 0
  v_mov_b32 v37, 0
  v_mov_b32 v38, 0
  v_mov_b32 v39, 0
  v_mov_b32 v40, 0
  v_mov_b32 v41, 0
  v_mov_b32 v42, 0
  v_mov_b32 v43, 0
  v_mov_b32 v44, 0
  v_mov_b32 v45, 0
  v_mov_b32 v46, 0
  v_mov_b32 v47, 0
  v_mov_b32 v48, 0
  v_mov_b32 v49, 0
  v_mov_b32 v50, 0
  v_mov_b32 v51, 0
  v_mov_b32 v52, 0
  v_mov_b32 v53, 0
  v_mov_b32 v54, 0
  v_mov_b32 v55, 0
  v_mov_b32 v56, 0
  v_mov_b32 v57, 0
  v_mov_b32 v58, 0
  v_mov_b32 v59, 0
  v_mov_b32 v60, 0
  v_mov_b32 v61, 0
  v_mov_b32 v62, 0
  v_mov_b32 v63, 0
  v_mov_b32 v64, 0
  v_mov_b32 v65, 0
  v_mov_b32 v66, 0
  v_mov_b32 v67, 0
  v_mov_b32 v68, 0
  v_mov_b32 v69, 0
  v_mov_b32 v70, 0
  v_mov_b32 v71, 0
  v_mov_b32 v72, 0
  v_mov_b32 v73, 0
  v_mov_b32 v74, 0
  v_mov_b32 v75, 0
  v_mov_b32 v76, 0
  v_mov_b32 v77, 0
  v_mov_b32 v78, 0
  v_mov_b32 v79, 0
  v_mov_b32 v80, 0
  v_mov_b32 v81, 0
  v_mov_b32 v82, 0
  v_mov_b32 v83, 0
  v_mov_b32 v84, 0
  v_mov_b32 v85, 0
  v_mov_b32 v86, 0
  v_mov_b32 v87, 0
  v_mov_b32 v88, 0
  v_mov_b32 v89, 0
  v_mov_b32 v90, 0
  v_mov_b32 v91, 0
  v_mov_b32 v92, 0
  v_mov_b32 v93, 0
  v_mov_b32 v94, 0
  v_mov_b32 v95, 0
  v_mov_b32 v96, 0
  v_mov_b32 v97, 0
  v_mov_b32 v98, 0
  v_mov_b32 v99, 0
  v_mov_b32 v100, 0
  v_mov_b32 v101, 0
  v_mov_b32 v102, 0
  v_mov_b32 v103, 0
  v_mov_b32 v104, 0
  v_mov_b32 v105, 0
  v_mov_b32 v106, 0
  v_mov_b32 v107, 0
  v_mov_b32 v108, 0
  v_mov_b32 v109, 0
  v_mov_b32 v110, 0
  v_mov_b32 v111, 0
  v_mov_b32 v112, 0
  v_mov_b32 v113, 0
  v_mov_b32 v114, 0
  v_mov_b32 v115, 0
  v_mov_b32 v116, 0
  v_mov_b32 v117, 0
  v_mov_b32 v118, 0
  v_mov_b32 v119, 0
  v_mov_b32 v120, 0
  v_mov_b32 v121, 0
  v_mov_b32 v122, 0
  v_mov_b32 v123, 0
  v_mov_b32 v124, 0
  v_mov_b32 v125, 0
  v_mov_b32 v126, 0
  v_mov_b32 v127, 0
  v_mov_b32 v128, 0
  v_mov_b32 v129, 0
  v_mov_b32 v130, 0
  v_mov_b32 v131, 0
  v_mov_b32 v132, 0
  v_mov_b32 v133, 0
  v_mov_b32 v134, 0
  v_mov_b32 v135, 0
  v_mov_b32 v136, 0
  v_mov_b32 v137, 0
  v_mov_b32 v138, 0
  v_mov_b32 v139, 0
  v_mov_b32 v140, 0
  v_mov_b32 v141, 0
  v_mov_b32 v142, 0
  v_mov_b32 v143, 0
  v_mov_b32 v144, 0
  v_mov_b32 v145, 0
  v_mov_b32 v146, 0
  v_mov_b32 v147, 0
  v_mov_b32 v148, 0
  v_mov_b32 v149, 0
  v_mov_b32 v150, 0
  v_mov_b32 v151, 0
  v_mov_b32 v152, 0
  v_mov_b32 v153, 0
  v_mov_b32 v154, 0
  v_mov_b32 v155, 0
  v_mov_b32 v156, 0
  v_mov_b32 v157, 0
  v_mov_b32 v158, 0
  v_mov_b32 v159, 0
  v_mov_b32 v184, 0x3f803f80
  v_mov_b32 v185, 0x3f803f80
  v_mov_b32 v186, 0x3f803f80
  v_mov_b32 v187, 0x3f803f80
  v_and_b32 v5, 15, v1
  v_lshrrev_b32 v6, 4, v1
  v_lshlrev_b32 v6, 2, v6
  s_mov_b32 s60, 9
  s_mov_b32 s61, 15
  s_mov_b32 s62, 9
  s_cmp_eq_u32 s59, 0
  s_cselect_b32 s60, 1, s60
  s_cselect_b32 s61, 7, s61
  s_or_b32 s63, s59, s58
  s_cmp_eq_u32 s63, 0
  s_cselect_b32 s60, 99, s60
  s_cselect_b32 s62, 99, s62
  v_mov_b32 v182, 0
  v_mov_b32 v183, 0
  v_mov_b32 v204, 0xff800000
  v_add_u32 v7, 0, v6
  v_sub_u32 v205, v5, v7
  v_cmp_ge_u32 vcc, 7, v205
  v_sub_u32 v206, v7, v5
  v_mov_b32 v207, 0xffff
  v_cndmask_b32 v170, v204, 0, vcc
  v_cndmask_b32 v207, 0, v207, vcc
  v_or_b32 v182, v182, v207
  v_cmp_le_i32 vcc, s60, v206
  v_cmp_ge_i32 s[64:65], s61, v7
  s_nop 0
  s_and_b64 vcc, vcc, s[64:65]
  s_nop 1
  v_cndmask_b32 v174, v204, 0, vcc
  v_cmp_le_i32 vcc, s62, v206
  s_nop 1
  v_cndmask_b32 v178, v204, 0, vcc
  v_add_u32 v7, 1, v6
  v_sub_u32 v205, v5, v7
  v_cmp_ge_u32 vcc, 7, v205
  v_sub_u32 v206, v7, v5
  v_mov_b32 v207, 0xffff0000
  v_cndmask_b32 v171, v204, 0, vcc
  v_cndmask_b32 v207, 0, v207, vcc
  v_or_b32 v182, v182, v207
  v_cmp_le_i32 vcc, s60, v206
  v_cmp_ge_i32 s[64:65], s61, v7
  s_nop 0
  s_and_b64 vcc, vcc, s[64:65]
  s_nop 1
  v_cndmask_b32 v175, v204, 0, vcc
  v_cmp_le_i32 vcc, s62, v206
  s_nop 1
  v_cndmask_b32 v179, v204, 0, vcc
  v_add_u32 v7, 2, v6
  v_sub_u32 v205, v5, v7
  v_cmp_ge_u32 vcc, 7, v205
  v_sub_u32 v206, v7, v5
  v_mov_b32 v207, 0xffff
  v_cndmask_b32 v172, v204, 0, vcc
  v_cndmask_b32 v207, 0, v207, vcc
  v_or_b32 v183, v183, v207
  v_cmp_le_i32 vcc, s60, v206
  v_cmp_ge_i32 s[64:65], s61, v7
  s_nop 0
  s_and_b64 vcc, vcc, s[64:65]
  s_nop 1
  v_cndmask_b32 v176, v204, 0, vcc
  v_cmp_le_i32 vcc, s62, v206
  s_nop 1
  v_cndmask_b32 v180, v204, 0, vcc
  v_add_u32 v7, 3, v6
  v_sub_u32 v205, v5, v7
  v_cmp_ge_u32 vcc, 7, v205
  v_sub_u32 v206, v7, v5
  v_mov_b32 v207, 0xffff0000
  v_cndmask_b32 v173, v204, 0, vcc
  v_cndmask_b32 v207, 0, v207, vcc
  v_or_b32 v183, v183, v207
  v_cmp_le_i32 vcc, s60, v206
  v_cmp_ge_i32 s[64:65], s61, v7
  s_nop 0
  s_and_b64 vcc, vcc, s[64:65]
  s_nop 1
  v_cndmask_b32 v177, v204, 0, vcc
  v_cmp_le_i32 vcc, s62, v206
  s_nop 1
  v_cndmask_b32 v181, v204, 0, vcc
  s_mov_b32 s66, 0xffff0000
  s_mov_b32 s67, -1
  s_mov_b32 s68, 0
  s_mov_b32 s69, -1
  s_mov_b32 s70, 0
  s_mov_b32 s71, 0xffff0000
  s_not_b64 s[72:73], s[66:67]
  s_not_b64 s[74:75], s[68:69]
  s_not_b64 s[76:77], s[70:71]
  s_waitcnt lgkmcnt(0)
  s_getpc_b64 s[92:93]
CWL_0:
  s_sub_u32 s92, s92, CWL_0-gm1_kernel
  s_subb_u32 s93, s93, 0
  s_lshl_b32 s94, s51, 2
  s_add_u32 s94, s94, s59
  s_mul_i32 s94, s94, 384
  s_min_u32 s94, s94, CODE_END-gm1_kernel-384
  s_add_u32 s92, s92, s94
  s_addc_u32 s93, s93, 0
  s_load_dword s95, s[92:93], 0
  s_load_dword s95, s[92:93], 64
  s_load_dword s95, s[92:93], 128
  s_load_dword s95, s[92:93], 192
  s_load_dword s95, s[92:93], 256
  s_load_dword s95, s[92:93], 320
  s_mov_b32 s24, s22
  s_and_b32 s25, s23, 0xffff
  s_mov_b32 s26, 8912896
  s_mov_b32 s27, 0x00020000
  s_lshl_b32 s36, s54, 1
  s_lshr_b32 s37, s59, 1
  s_add_u32 s36, s36, s37
  s_mul_i32 s36, s36, 68
  s_mul_i32 s37, s55, 5
  s_lshr_b32 s37, s37, 1
  s_add_u32 s36, s36, s37
  s_lshl_b32 s36, s36, 12
  s_and_b32 s37, s59, 1
  s_lshl_b32 s37, s37, 11
  s_add_u32 s36, s36, s37
  s_add_u32 s37, s36, 4096
  s_add_u32 s38, s36, 8192
  s_mov_b32 s47, 0
  s_mov_b32 s48, 10
  v_mov_b32 v5, v2
  v_mov_b32 v6, v3
  v_mov_b32 v7, v4
  v_mov_b32 v188, 0
  v_mov_b32 v189, 0
  v_mov_b32 v190, 0
  v_mov_b32 v191, 0
  v_mov_b32 v192, 0
  v_mov_b32 v193, 0
  v_mov_b32 v194, 0
  v_mov_b32 v195, 0
  v_mov_b32 v196, 0
  v_mov_b32 v197, 0
  v_mov_b32 v198, 0
  v_mov_b32 v199, 0
  s_cmp_eq_u32 s59, 1
  s_cbranch_scc1 QC1_ENT
  s_cmp_eq_u32 s59, 2
  s_cbranch_scc1 QC2_ENT
  s_cmp_eq_u32 s59, 3
  s_cbranch_scc1 QC3_ENT
QC0_ENT:
  s_mov_b32 s48, 10
  s_barrier
  ds_read_b128 a[24:27], v6 offset:2048
  ds_read_b64_tr_b16 a[0:1], v5 offset:0
  ds_read_b64_tr_b16 a[2:3], v5 offset:3840
  ds_read_b128 a[28:31], v6 offset:4096
  ds_read_b64_tr_b16 a[4:5], v5 offset:32
  ds_read_b64_tr_b16 a[6:7], v5 offset:3872
  ds_read_b64_tr_b16 a[8:9], v5 offset:64
  ds_read_b64_tr_b16 a[10:11], v5 offset:3904
  ds_read_b128 a[40:43], v6
  ds_read_b64_tr_b16 a[12:13], v5 offset:96
  ds_read_b64_tr_b16 a[14:15], v5 offset:3936
  ds_read_b64_tr_b16 a[16:17], v5 offset:128
  ds_read_b64_tr_b16 a[18:19], v5 offset:3968
  ds_read_b64_tr_b16 a[20:21], v5 offset:160
  ds_read_b64_tr_b16 a[22:23], v5 offset:4000
QC0_LOOP:
  s_waitcnt lgkmcnt(12)
  v_mfma_f32_16x16x32_bf16 v[8:11], a[0:3], a[24:27], v[8:11]
  s_waitcnt lgkmcnt(11)
  v_mfma_f32_16x16x32_bf16 v[68:71], a[0:3], a[28:31], v[68:71]
  ds_read_b64_tr_b16 a[0:1], v5 offset:192
  s_waitcnt lgkmcnt(10)
  v_mfma_f32_16x16x32_bf16 v[12:15], a[4:7], a[24:27], v[12:15]
  ds_read_b64_tr_b16 a[2:3], v5 offset:4032
  v_mfma_f32_16x16x32_bf16 v[72:75], a[4:7], a[28:31], v[72:75]
  ds_read_b64_tr_b16 a[4:5], v5 offset:224
  s_waitcnt lgkmcnt(10)
  v_mfma_f32_16x16x32_bf16 v[16:19], a[8:11], a[24:27], v[16:19]
  ds_read_b64_tr_b16 a[6:7], v5 offset:4064
  v_mfma_f32_16x16x32_bf16 v[76:79], a[8:11], a[28:31], v[76:79]
  ds_read_b64_tr_b16 a[8:9], v5 offset:256
  s_waitcnt lgkmcnt(9)
  v_mfma_f32_16x16x32_bf16 v[20:23], a[12:15], a[24:27], v[20:23]
  ds_read_b64_tr_b16 a[10:11], v5 offset:4096
  v_mfma_f32_16x16x32_bf16 v[80:83], a[12:15], a[28:31], v[80:83]
  ds_read_b64_tr_b16 a[12:13], v5 offset:288
  s_waitcnt lgkmcnt(9)
  v_mfma_f32_16x16x32_bf16 v[24:27], a[16:19], a[24:27], v[24:27]
  ds_read_b64_tr_b16 a[14:15], v5 offset:4128
  v_mfma_f32_16x16x32_bf16 v[84:87], a[16:19], a[28:31], v[84:87]
  ds_read_b64_tr_b16 a[16:17], v5 offset:320
  s_waitcnt lgkmcnt(9)
  v_mfma_f32_16x16x32_bf16 v[28:31], a[20:23], a[24:27], v[28:31]
  ds_read_b64_tr_b16 a[18:19], v5 offset:4160
  v_mfma_f32_16x16x32_bf16 v[88:91], a[20:23], a[28:31], v[88:91]
  v_mfma_f32_16x16x32_bf16 v[188:191], a[20:23], a[40:43], v[188:191]
  ds_read_b64_tr_b16 a[20:21], v5 offset:352
  s_waitcnt lgkmcnt(9)
  v_mfma_f32_16x16x32_bf16 v[32:35], a[0:3], a[24:27], v[32:35]
  ds_read_b64_tr_b16 a[22:23], v5 offset:4192
  v_mfma_f32_16x16x32_bf16 v[92:95], a[0:3], a[28:31], v[92:95]
  ds_read_b64_tr_b16 a[0:1], v5 offset:384
  s_waitcnt lgkmcnt(9)
  v_mfma_f32_16x16x32_bf16 v[36:39], a[4:7], a[24:27], v[36:39]
  ds_read_b64_tr_b16 a[2:3], v5 offset:4224
  v_mfma_f32_16x16x32_bf16 v[96:99], a[4:7], a[28:31], v[96:99]
  ds_read_b64_tr_b16 a[4:5], v5 offset:416
  s_waitcnt lgkmcnt(9)
  v_mfma_f32_16x16x32_bf16 v[40:43], a[8:11], a[24:27], v[40:43]
  ds_read_b64_tr_b16 a[6:7], v5 offset:4256
  v_mfma_f32_16x16x32_bf16 v[100:103], a[8:11], a[28:31], v[100:103]
  ds_read_b64_tr_b16 a[8:9], v5 offset:448
  ds_read_b64_tr_b16 a[10:11], v5 offset:4288
  s_waitcnt lgkmcnt(10)
  v_mfma_f32_16x16x32_bf16 v[44:47], a[12:15], a[24:27], v[44:47]
  ds_read_b128 a[32:35], v7 offset:2048
  v_mfma_f32_16x16x32_bf16 v[104:107], a[12:15], a[28:31], v[104:107]
  v_mfma_f32_16x16x32_bf16 v[196:199], a[12:15], a[40:43], v[196:199]
  ds_read_b64_tr_b16 a[12:13], v5 offset:15360
  ds_read_b64_tr_b16 a[14:15], v5 offset:19200
  s_waitcnt lgkmcnt(11)
  v_mfma_f32_16x16x32_bf16 v[48:51], a[24:27], a[16:19], v[48:51]
  ds_read_b128 a[36:39], v7 offset:4096
  v_mfma_f32_16x16x32_bf16 v[108:111], a[28:31], a[16:19], v[108:111]
  v_mfma_f32_16x16x32_bf16 v[192:195], a[40:43], a[16:19], v[192:195]
  ds_read_b64_tr_b16 a[16:17], v5 offset:15392
  ds_read_b64_tr_b16 a[18:19], v5 offset:19232
  s_waitcnt lgkmcnt(12)
  v_mfma_f32_16x16x32_bf16 v[52:55], a[24:27], a[20:23], v[52:55]
  ds_read_b128 a[44:47], v7
  v_mfma_f32_16x16x32_bf16 v[112:115], a[28:31], a[20:23], v[112:115]
  ds_read_b64_tr_b16 a[20:21], v5 offset:15424
  s_waitcnt lgkmcnt(12)
  v_mfma_f32_16x16x32_bf16 v[56:59], a[24:27], a[0:3], v[56:59]
  ds_read_b64_tr_b16 a[22:23], v5 offset:19264
  v_mfma_f32_16x16x32_bf16 v[116:119], a[28:31], a[0:3], v[116:119]
  ds_read_b64_tr_b16 a[0:1], v5 offset:15456
  s_waitcnt lgkmcnt(12)
  v_mfma_f32_16x16x32_bf16 v[60:63], a[24:27], a[4:7], v[60:63]
  ds_read_b64_tr_b16 a[2:3], v5 offset:19296
  v_mfma_f32_16x16x32_bf16 v[120:123], a[28:31], a[4:7], v[120:123]
  ds_read_b64_tr_b16 a[4:5], v5 offset:15488
  s_waitcnt lgkmcnt(12)
  v_mfma_f32_16x16x32_bf16 v[64:67], a[24:27], a[8:11], v[64:67]
  ds_read_b64_tr_b16 a[6:7], v5 offset:19328
  v_mfma_f32_16x16x32_bf16 v[124:127], a[28:31], a[8:11], v[124:127]
  ds_read_b64_tr_b16 a[8:9], v5 offset:15520
  s_waitcnt lgkmcnt(11)
  v_mfma_f32_16x16x32_bf16 v[8:11], a[12:15], a[32:35], v[8:11]
  ds_read_b64_tr_b16 a[10:11], v5 offset:19360
  s_waitcnt lgkmcnt(11)
  v_mfma_f32_16x16x32_bf16 v[68:71], a[12:15], a[36:39], v[68:71]
  ds_read_b64_tr_b16 a[12:13], v5 offset:15552
  s_waitcnt lgkmcnt(10)
  v_mfma_f32_16x16x32_bf16 v[12:15], a[16:19], a[32:35], v[12:15]
  ds_read_b64_tr_b16 a[14:15], v5 offset:19392
  v_mfma_f32_16x16x32_bf16 v[72:75], a[16:19], a[36:39], v[72:75]
  ds_read_b64_tr_b16 a[16:17], v5 offset:15584
  s_waitcnt lgkmcnt(9)
  v_mfma_f32_16x16x32_bf16 v[16:19], a[20:23], a[32:35], v[16:19]
  ds_read_b64_tr_b16 a[18:19], v5 offset:19424
  v_mfma_f32_16x16x32_bf16 v[76:79], a[20:23], a[36:39], v[76:79]
  ds_read_b64_tr_b16 a[20:21], v5 offset:15616
  s_waitcnt lgkmcnt(9)
  v_mfma_f32_16x16x32_bf16 v[20:23], a[0:3], a[32:35], v[20:23]
  ds_read_b64_tr_b16 a[22:23], v5 offset:19456
  v_mfma_f32_16x16x32_bf16 v[80:83], a[0:3], a[36:39], v[80:83]
  ds_read_b64_tr_b16 a[0:1], v5 offset:15648
  s_waitcnt lgkmcnt(9)
  v_mfma_f32_16x16x32_bf16 v[24:27], a[4:7], a[32:35], v[24:27]
  ds_read_b64_tr_b16 a[2:3], v5 offset:19488
  v_mfma_f32_16x16x32_bf16 v[84:87], a[4:7], a[36:39], v[84:87]
  ds_read_b64_tr_b16 a[4:5], v5 offset:15680
  s_waitcnt lgkmcnt(9)
  v_mfma_f32_16x16x32_bf16 v[28:31], a[8:11], a[32:35], v[28:31]
  ds_read_b64_tr_b16 a[6:7], v5 offset:19520
  v_mfma_f32_16x16x32_bf16 v[88:91], a[8:11], a[36:39], v[88:91]
  v_mfma_f32_16x16x32_bf16 v[188:191], a[8:11], a[44:47], v[188:191]
  ds_read_b64_tr_b16 a[8:9], v5 offset:15712
  s_waitcnt lgkmcnt(9)
  v_mfma_f32_16x16x32_bf16 v[32:35], a[12:15], a[32:35], v[32:35]
  ds_read_b64_tr_b16 a[10:11], v5 offset:19552
  v_mfma_f32_16x16x32_bf16 v[92:95], a[12:15], a[36:39], v[92:95]
  ds_read_b64_tr_b16 a[12:13], v5 offset:15744
  s_waitcnt lgkmcnt(9)
  v_mfma_f32_16x16x32_bf16 v[36:39], a[16:19], a[32:35], v[36:39]
  ds_read_b64_tr_b16 a[14:15], v5 offset:19584
  v_mfma_f32_16x16x32_bf16 v[96:99], a[16:19], a[36:39], v[96:99]
  ds_read_b64_tr_b16 a[16:17], v5 offset:15776
  s_waitcnt lgkmcnt(9)
  v_mfma_f32_16x16x32_bf16 v[40:43], a[20:23], a[32:35], v[40:43]
  ds_read_b64_tr_b16 a[18:19], v5 offset:19616
  v_mfma_f32_16x16x32_bf16 v[100:103], a[20:23], a[36:39], v[100:103]
  ds_read_b64_tr_b16 a[20:21], v5 offset:15808
  ds_read_b64_tr_b16 a[22:23], v5 offset:19648
  s_waitcnt lgkmcnt(10)
  v_mfma_f32_16x16x32_bf16 v[44:47], a[0:3], a[32:35], v[44:47]
  s_add_u32 s47, s47, 49152
  s_cmp_eq_u32 s47, 147456
  v_mfma_f32_16x16x32_bf16 v[104:107], a[0:3], a[36:39], v[104:107]
  s_cselect_b32 s47, 0, s47
  v_mfma_f32_16x16x32_bf16 v[196:199], a[0:3], a[44:47], v[196:199]
  v_add_u32 v5, s47, v2
  v_add_u32 v6, s47, v3
  s_waitcnt lgkmcnt(8)
  v_mfma_f32_16x16x32_bf16 v[48:51], a[32:35], a[4:7], v[48:51]
  v_add_u32 v7, s47, v4
  s_sub_u32 s48, s48, 1
  v_mfma_f32_16x16x32_bf16 v[108:111], a[36:39], a[4:7], v[108:111]
  v_mfma_f32_16x16x32_bf16 v[192:195], a[44:47], a[4:7], v[192:195]
  s_waitcnt lgkmcnt(6)
  v_mfma_f32_16x16x32_bf16 v[52:55], a[32:35], a[8:11], v[52:55]
  v_mfma_f32_16x16x32_bf16 v[112:115], a[36:39], a[8:11], v[112:115]
  s_waitcnt lgkmcnt(0)
  s_barrier
  v_mfma_f32_16x16x32_bf16 v[56:59], a[32:35], a[12:15], v[56:59]
  ds_read_b128 a[24:27], v6 offset:2048
  ds_read_b64_tr_b16 a[0:1], v5 offset:0
  v_mfma_f32_16x16x32_bf16 v[116:119], a[36:39], a[12:15], v[116:119]
  ds_read_b64_tr_b16 a[2:3], v5 offset:3840
  ds_read_b128 a[28:31], v6 offset:4096
  v_mfma_f32_16x16x32_bf16 v[60:63], a[32:35], a[16:19], v[60:63]
  ds_read_b64_tr_b16 a[4:5], v5 offset:32
  ds_read_b64_tr_b16 a[6:7], v5 offset:3872
  v_mfma_f32_16x16x32_bf16 v[120:123], a[36:39], a[16:19], v[120:123]
  ds_read_b64_tr_b16 a[8:9], v5 offset:64
  ds_read_b64_tr_b16 a[10:11], v5 offset:3904
  v_mfma_f32_16x16x32_bf16 v[64:67], a[32:35], a[20:23], v[64:67]
  ds_read_b128 a[40:43], v6
  ds_read_b64_tr_b16 a[12:13], v5 offset:96
  v_mfma_f32_16x16x32_bf16 v[124:127], a[36:39], a[20:23], v[124:127]
  s_cmp_lg_u32 s48, 0
  ds_read_b64_tr_b16 a[14:15], v5 offset:3936
  ds_read_b64_tr_b16 a[16:17], v5 offset:128
  ds_read_b64_tr_b16 a[18:19], v5 offset:3968
  ds_read_b64_tr_b16 a[20:21], v5 offset:160
  ds_read_b64_tr_b16 a[22:23], v5 offset:4000
  s_cbranch_scc1 QC0_LOOP
  v_lshlrev_b32 v5, 3, v1
  v_add_u32 v5, 49152, v5
  s_nop 7
  v_cvt_pk_bf16_f32 v188, v188, v189
  v_cvt_pk_bf16_f32 v189, v190, v191
  v_cvt_pk_bf16_f32 v192, v192, v193
  v_cvt_pk_bf16_f32 v193, v194, v195
  v_cvt_pk_bf16_f32 v196, v196, v197
  v_cvt_pk_bf16_f32 v197, v198, v199
  ds_write_b64 v5, v[188:189] offset:0
  ds_write_b64 v5, v[192:193] offset:2560
  ds_write_b64 v5, v[196:197] offset:2048
  ds_write_b64 v5, v[188:189] offset:5120
  ds_write_b64 v5, v[192:193] offset:7680
  ds_write_b64 v5, v[196:197] offset:7168
  s_branch QC_EPI
QC1_ENT:
  s_mov_b32 s48, 10
  s_barrier
  ds_read_b128 a[24:27], v6 offset:6144
  ds_read_b64_tr_b16 a[0:1], v5 offset:0
  ds_read_b64_tr_b16 a[2:3], v5 offset:3840
  ds_read_b128 a[28:31], v6 offset:8192
  ds_read_b64_tr_b16 a[4:5], v5 offset:32
  ds_read_b64_tr_b16 a[6:7], v5 offset:3872
  ds_read_b64_tr_b16 a[8:9], v5 offset:64
  ds_read_b64_tr_b16 a[10:11], v5 offset:3904
  ds_read_b128 a[40:43], v6
  ds_read_b64_tr_b16 a[12:13], v5 offset:96
  ds_read_b64_tr_b16 a[14:15], v5 offset:3936
  ds_read_b64_tr_b16 a[16:17], v5 offset:128
  ds_read_b64_tr_b16 a[18:19], v5 offset:3968
  ds_read_b64_tr_b16 a[20:21], v5 offset:160
  ds_read_b64_tr_b16 a[22:23], v5 offset:4000
QC1_LOOP:
  s_waitcnt lgkmcnt(12)
  v_mfma_f32_16x16x32_bf16 v[8:11], a[0:3], a[24:27], v[8:11]
  s_waitcnt lgkmcnt(11)
  v_mfma_f32_16x16x32_bf16 v[68:71], a[0:3], a[28:31], v[68:71]
  ds_read_b64_tr_b16 a[0:1], v5 offset:192
  s_waitcnt lgkmcnt(10)
  v_mfma_f32_16x16x32_bf16 v[12:15], a[4:7], a[24:27], v[12:15]
  ds_read_b64_tr_b16 a[2:3], v5 offset:4032
  v_mfma_f32_16x16x32_bf16 v[72:75], a[4:7], a[28:31], v[72:75]
  ds_read_b64_tr_b16 a[4:5], v5 offset:224
  s_waitcnt lgkmcnt(10)
  v_mfma_f32_16x16x32_bf16 v[16:19], a[8:11], a[24:27], v[16:19]
  ds_read_b64_tr_b16 a[6:7], v5 offset:4064
  v_mfma_f32_16x16x32_bf16 v[76:79], a[8:11], a[28:31], v[76:79]
  ds_read_b64_tr_b16 a[8:9], v5 offset:256
  s_waitcnt lgkmcnt(9)
  v_mfma_f32_16x16x32_bf16 v[20:23], a[12:15], a[24:27], v[20:23]
  ds_read_b64_tr_b16 a[10:11], v5 offset:4096
  v_mfma_f32_16x16x32_bf16 v[80:83], a[12:15], a[28:31], v[80:83]
  ds_read_b64_tr_b16 a[12:13], v5 offset:288
  s_waitcnt lgkmcnt(9)
  v_mfma_f32_16x16x32_bf16 v[24:27], a[16:19], a[24:27], v[24:27]
  ds_read_b64_tr_b16 a[14:15], v5 offset:4128
  v_mfma_f32_16x16x32_bf16 v[84:87], a[16:19], a[28:31], v[84:87]
  ds_read_b64_tr_b16 a[16:17], v5 offset:320
  s_waitcnt lgkmcnt(9)
  v_mfma_f32_16x16x32_bf16 v[28:31], a[20:23], a[24:27], v[28:31]
  ds_read_b64_tr_b16 a[18:19], v5 offset:4160
  v_mfma_f32_16x16x32_bf16 v[88:91], a[20:23], a[28:31], v[88:91]
  ds_read_b64_tr_b16 a[20:21], v5 offset:352
  s_waitcnt lgkmcnt(9)
  v_mfma_f32_16x16x32_bf16 v[32:35], a[0:3], a[24:27], v[32:35]
  ds_read_b64_tr_b16 a[22:23], v5 offset:4192
  v_mfma_f32_16x16x32_bf16 v[92:95], a[0:3], a[28:31], v[92:95]
  v_mfma_f32_16x16x32_bf16 v[188:191], a[0:3], a[40:43], v[188:191]
  ds_read_b64_tr_b16 a[0:1], v5 offset:384
  s_waitcnt lgkmcnt(9)
  v_mfma_f32_16x16x32_bf16 v[36:39], a[4:7], a[24:27], v[36:39]
  ds_read_b64_tr_b16 a[2:3], v5 offset:4224
  v_mfma_f32_16x16x32_bf16 v[96:99], a[4:7], a[28:31], v[96:99]
  ds_read_b64_tr_b16 a[4:5], v5 offset:416
  s_waitcnt lgkmcnt(9)
  v_mfma_f32_16x16x32_bf16 v[40:43], a[8:11], a[24:27], v[40:43]
  ds_read_b64_tr_b16 a[6:7], v5 offset:4256
  v_mfma_f32_16x16x32_bf16 v[100:103], a[8:11], a[28:31], v[100:103]
  ds_read_b64_tr_b16 a[8:9], v5 offset:448
  ds_read_b64_tr_b16 a[10:11], v5 offset:4288
  s_waitcnt lgkmcnt(10)
  v_mfma_f32_16x16x32_bf16 v[44:47], a[12:15], a[24:27], v[44:47]
  ds_read_b128 a[32:35], v7 offset:6144
  v_mfma_f32_16x16x32_bf16 v[104:107], a[12:15], a[28:31], v[104:107]
  ds_read_b64_tr_b16 a[12:13], v5 offset:15360
  ds_read_b64_tr_b16 a[14:15], v5 offset:19200
  s_waitcnt lgkmcnt(11)
  v_mfma_f32_16x16x32_bf16 v[48:51], a[24:27], a[16:19], v[48:51]
  ds_read_b128 a[36:39], v7 offset:8192
  v_mfma_f32_16x16x32_bf16 v[108:111], a[28:31], a[16:19], v[108:111]
  ds_read_b64_tr_b16 a[16:17], v5 offset:15392
  ds_read_b64_tr_b16 a[18:19], v5 offset:19232
  s_waitcnt lgkmcnt(12)
  v_mfma_f32_16x16x32_bf16 v[52:55], a[24:27], a[20:23], v[52:55]
  ds_read_b128 a[44:47], v7
  v_mfma_f32_16x16x32_bf16 v[112:115], a[28:31], a[20:23], v[112:115]
  v_mfma_f32_16x16x32_bf16 v[192:195], a[40:43], a[20:23], v[192:195]
  ds_read_b64_tr_b16 a[20:21], v5 offset:15424
  s_waitcnt lgkmcnt(12)
  v_mfma_f32_16x16x32_bf16 v[56:59], a[24:27], a[0:3], v[56:59]
  ds_read_b64_tr_b16 a[22:23], v5 offset:19264
  v_mfma_f32_16x16x32_bf16 v[116:119], a[28:31], a[0:3], v[116:119]
  ds_read_b64_tr_b16 a[0:1], v5 offset:15456
  s_waitcnt lgkmcnt(12)
  v_mfma_f32_16x16x32_bf16 v[60:63], a[24:27], a[4:7], v[60:63]
  ds_read_b64_tr_b16 a[2:3], v5 offset:19296
  v_mfma_f32_16x16x32_bf16 v[120:123], a[28:31], a[4:7], v[120:123]
  ds_read_b64_tr_b16 a[4:5], v5 offset:15488
  s_waitcnt lgkmcnt(12)
  v_mfma_f32_16x16x32_bf16 v[64:67], a[24:27], a[8:11], v[64:67]
  ds_read_b64_tr_b16 a[6:7], v5 offset:19328
  v_mfma_f32_16x16x32_bf16 v[124:127], a[28:31], a[8:11], v[124:127]
  v_mfma_f32_16x16x32_bf16 v[196:199], a[40:43], a[8:11], v[196:199]
  ds_read_b64_tr_b16 a[8:9], v5 offset:15520
  s_waitcnt lgkmcnt(11)
  v_mfma_f32_16x16x32_bf16 v[8:11], a[12:15], a[32:35], v[8:11]
  ds_read_b64_tr_b16 a[10:11], v5 offset:19360
  s_waitcnt lgkmcnt(11)
  v_mfma_f32_16x16x32_bf16 v[68:71], a[12:15], a[36:39], v[68:71]
  ds_read_b64_tr_b16 a[12:13], v5 offset:15552
  s_waitcnt lgkmcnt(10)
  v_mfma_f32_16x16x32_bf16 v[12:15], a[16:19], a[32:35], v[12:15]
  ds_read_b64_tr_b16 a[14:15], v5 offset:19392
  v_mfma_f32_16x16x32_bf16 v[72:75], a[16:19], a[36:39], v[72:75]
  ds_read_b64_tr_b16 a[16:17], v5 offset:15584
  s_waitcnt lgkmcnt(9)
  v_mfma_f32_16x16x32_bf16 v[16:19], a[20:23], a[32:35], v[16:19]
  ds_read_b64_tr_b16 a[18:19], v5 offset:19424
  v_mfma_f32_16x16x32_bf16 v[76:79], a[20:23], a[36:39], v[76:79]
  ds_read_b64_tr_b16 a[20:21], v5 offset:15616
  s_waitcnt lgkmcnt(9)
  v_mfma_f32_16x16x32_bf16 v[20:23], a[0:3], a[32:35], v[20:23]
  ds_read_b64_tr_b16 a[22:23], v5 offset:19456
  v_mfma_f32_16x16x32_bf16 v[80:83], a[0:3], a[36:39], v[80:83]
  ds_read_b64_tr_b16 a[0:1], v5 offset:15648
  s_waitcnt lgkmcnt(9)
  v_mfma_f32_16x16x32_bf16 v[24:27], a[4:7], a[32:35], v[24:27]
  ds_read_b64_tr_b16 a[2:3], v5 offset:19488
  v_mfma_f32_16x16x32_bf16 v[84:87], a[4:7], a[36:39], v[84:87]
  ds_read_b64_tr_b16 a[4:5], v5 offset:15680
  s_waitcnt lgkmcnt(9)
  v_mfma_f32_16x16x32_bf16 v[28:31], a[8:11], a[32:35], v[28:31]
  ds_read_b64_tr_b16 a[6:7], v5 offset:19520
  v_mfma_f32_16x16x32_bf16 v[88:91], a[8:11], a[36:39], v[88:91]
  ds_read_b64_tr_b16 a[8:9], v5 offset:15712
  s_waitcnt lgkmcnt(9)
  v_mfma_f32_16x16x32_bf16 v[32:35], a[12:15], a[32:35], v[32:35]
  ds_read_b64_tr_b16 a[10:11], v5 offset:19552
  v_mfma_f32_16x16x32_bf16 v[92:95], a[12:15], a[36:39], v[92:95]
  v_mfma_f32_16x16x32_bf16 v[188:191], a[12:15], a[44:47], v[188:191]
  ds_read_b64_tr_b16 a[12:13], v5 offset:15744
  s_waitcnt lgkmcnt(9)
  v_mfma_f32_16x16x32_bf16 v[36:39], a[16:19], a[32:35], v[36:39]
  ds_read_b64_tr_b16 a[14:15], v5 offset:19584
  v_mfma_f32_16x16x32_bf16 v[96:99], a[16:19], a[36:39], v[96:99]
  ds_read_b64_tr_b16 a[16:17], v5 offset:15776
  s_waitcnt lgkmcnt(9)
  v_mfma_f32_16x16x32_bf16 v[40:43], a[20:23], a[32:35], v[40:43]
  ds_read_b64_tr_b16 a[18:19], v5 offset:19616
  v_mfma_f32_16x16x32_bf16 v[100:103], a[20:23], a[36:39], v[100:103]
  ds_read_b64_tr_b16 a[20:21], v5 offset:15808
  ds_read_b64_tr_b16 a[22:23], v5 offset:19648
  s_waitcnt lgkmcnt(10)
  v_mfma_f32_16x16x32_bf16 v[44:47], a[0:3], a[32:35], v[44:47]
  s_add_u32 s47, s47, 49152
  s_cmp_eq_u32 s47, 147456
  v_mfma_f32_16x16x32_bf16 v[104:107], a[0:3], a[36:39], v[104:107]
  s_cselect_b32 s47, 0, s47
  v_add_u32 v5, s47, v2
  s_waitcnt lgkmcnt(8)
  v_mfma_f32_16x16x32_bf16 v[48:51], a[32:35], a[4:7], v[48:51]
  v_add_u32 v6, s47, v3
  v_add_u32 v7, s47, v4
  v_mfma_f32_16x16x32_bf16 v[108:111], a[36:39], a[4:7], v[108:111]
  s_sub_u32 s48, s48, 1
  s_waitcnt lgkmcnt(6)
  v_mfma_f32_16x16x32_bf16 v[52:55], a[32:35], a[8:11], v[52:55]
  v_mfma_f32_16x16x32_bf16 v[112:115], a[36:39], a[8:11], v[112:115]
  v_mfma_f32_16x16x32_bf16 v[192:195], a[44:47], a[8:11], v[192:195]
  s_waitcnt lgkmcnt(0)
  s_barrier
  v_mfma_f32_16x16x32_bf16 v[56:59], a[32:35], a[12:15], v[56:59]
  ds_read_b128 a[24:27], v6 offset:6144
  ds_read_b64_tr_b16 a[0:1], v5 offset:0
  v_mfma_f32_16x16x32_bf16 v[116:119], a[36:39], a[12:15], v[116:119]
  ds_read_b64_tr_b16 a[2:3], v5 offset:3840
  ds_read_b128 a[28:31], v6 offset:8192
  v_mfma_f32_16x16x32_bf16 v[60:63], a[32:35], a[16:19], v[60:63]
  ds_read_b64_tr_b16 a[4:5], v5 offset:32
  ds_read_b64_tr_b16 a[6:7], v5 offset:3872
  v_mfma_f32_16x16x32_bf16 v[120:123], a[36:39], a[16:19], v[120:123]
  ds_read_b64_tr_b16 a[8:9], v5 offset:64
  ds_read_b64_tr_b16 a[10:11], v5 offset:3904
  v_mfma_f32_16x16x32_bf16 v[64:67], a[32:35], a[20:23], v[64:67]
  ds_read_b128 a[40:43], v6
  ds_read_b64_tr_b16 a[12:13], v5 offset:96
  v_mfma_f32_16x16x32_bf16 v[124:127], a[36:39], a[20:23], v[124:127]
  ds_read_b64_tr_b16 a[14:15], v5 offset:3936
  v_mfma_f32_16x16x32_bf16 v[196:199], a[44:47], a[20:23], v[196:199]
  s_cmp_lg_u32 s48, 0
  ds_read_b64_tr_b16 a[16:17], v5 offset:128
  ds_read_b64_tr_b16 a[18:19], v5 offset:3968
  ds_read_b64_tr_b16 a[20:21], v5 offset:160
  ds_read_b64_tr_b16 a[22:23], v5 offset:4000
  s_cbranch_scc1 QC1_LOOP
  v_lshlrev_b32 v5, 3, v1
  v_add_u32 v5, 49152, v5
  s_nop 7
  v_cvt_pk_bf16_f32 v188, v188, v189
  v_cvt_pk_bf16_f32 v189, v190, v191
  v_cvt_pk_bf16_f32 v192, v192, v193
  v_cvt_pk_bf16_f32 v193, v194, v195
  v_cvt_pk_bf16_f32 v196, v196, v197
  v_cvt_pk_bf16_f32 v197, v198, v199
  ds_write_b64 v5, v[188:189] offset:512
  ds_write_b64 v5, v[192:193] offset:3072
  ds_write_b64 v5, v[196:197] offset:4608
  ds_write_b64 v5, v[188:189] offset:5632
  ds_write_b64 v5, v[192:193] offset:8192
  ds_write_b64 v5, v[196:197] offset:9728
  s_branch QC_EPI
QC2_ENT:
  s_mov_b32 s48, 10
  s_barrier
  ds_read_b128 a[24:27], v6 offset:10240
  ds_read_b64_tr_b16 a[0:1], v5 offset:0
  ds_read_b64_tr_b16 a[2:3], v5 offset:3840
  ds_read_b128 a[28:31], v6 offset:12288
  ds_read_b64_tr_b16 a[4:5], v5 offset:32
  ds_read_b64_tr_b16 a[6:7], v5 offset:3872
  ds_read_b64_tr_b16 a[8:9], v5 offset:64
  ds_read_b64_tr_b16 a[10:11], v5 offset:3904
  ds_read_b128 a[40:43], v6
  ds_read_b64_tr_b16 a[12:13], v5 offset:96
  ds_read_b64_tr_b16 a[14:15], v5 offset:3936
  ds_read_b64_tr_b16 a[16:17], v5 offset:128
  ds_read_b64_tr_b16 a[18:19], v5 offset:3968
  ds_read_b64_tr_b16 a[20:21], v5 offset:160
  ds_read_b64_tr_b16 a[22:23], v5 offset:4000
QC2_LOOP:
  s_waitcnt lgkmcnt(12)
  v_mfma_f32_16x16x32_bf16 v[8:11], a[0:3], a[24:27], v[8:11]
  s_waitcnt lgkmcnt(11)
  v_mfma_f32_16x16x32_bf16 v[68:71], a[0:3], a[28:31], v[68:71]
  ds_read_b64_tr_b16 a[0:1], v5 offset:192
  s_waitcnt lgkmcnt(10)
  v_mfma_f32_16x16x32_bf16 v[12:15], a[4:7], a[24:27], v[12:15]
  ds_read_b64_tr_b16 a[2:3], v5 offset:4032
  v_mfma_f32_16x16x32_bf16 v[72:75], a[4:7], a[28:31], v[72:75]
  ds_read_b64_tr_b16 a[4:5], v5 offset:224
  s_waitcnt lgkmcnt(10)
  v_mfma_f32_16x16x32_bf16 v[16:19], a[8:11], a[24:27], v[16:19]
  ds_read_b64_tr_b16 a[6:7], v5 offset:4064
  v_mfma_f32_16x16x32_bf16 v[76:79], a[8:11], a[28:31], v[76:79]
  ds_read_b64_tr_b16 a[8:9], v5 offset:256
  s_waitcnt lgkmcnt(9)
  v_mfma_f32_16x16x32_bf16 v[20:23], a[12:15], a[24:27], v[20:23]
  ds_read_b64_tr_b16 a[10:11], v5 offset:4096
  v_mfma_f32_16x16x32_bf16 v[80:83], a[12:15], a[28:31], v[80:83]
  ds_read_b64_tr_b16 a[12:13], v5 offset:288
  s_waitcnt lgkmcnt(9)
  v_mfma_f32_16x16x32_bf16 v[24:27], a[16:19], a[24:27], v[24:27]
  ds_read_b64_tr_b16 a[14:15], v5 offset:4128
  v_mfma_f32_16x16x32_bf16 v[84:87], a[16:19], a[28:31], v[84:87]
  ds_read_b64_tr_b16 a[16:17], v5 offset:320
  s_waitcnt lgkmcnt(9)
  v_mfma_f32_16x16x32_bf16 v[28:31], a[20:23], a[24:27], v[28:31]
  ds_read_b64_tr_b16 a[18:19], v5 offset:4160
  v_mfma_f32_16x16x32_bf16 v[88:91], a[20:23], a[28:31], v[88:91]
  ds_read_b64_tr_b16 a[20:21], v5 offset:352
  s_waitcnt lgkmcnt(9)
  v_mfma_f32_16x16x32_bf16 v[32:35], a[0:3], a[24:27], v[32:35]
  ds_read_b64_tr_b16 a[22:23], v5 offset:4192
  v_mfma_f32_16x16x32_bf16 v[92:95], a[0:3], a[28:31], v[92:95]
  ds_read_b64_tr_b16 a[0:1], v5 offset:384
  s_waitcnt lgkmcnt(9)
  v_mfma_f32_16x16x32_bf16 v[36:39], a[4:7], a[24:27], v[36:39]
  ds_read_b64_tr_b16 a[2:3], v5 offset:4224
  v_mfma_f32_16x16x32_bf16 v[96:99], a[4:7], a[28:31], v[96:99]
  v_mfma_f32_16x16x32_bf16 v[188:191], a[4:7], a[40:43], v[188:191]
  ds_read_b64_tr_b16 a[4:5], v5 offset:416
  s_waitcnt lgkmcnt(9)
  v_mfma_f32_16x16x32_bf16 v[40:43], a[8:11], a[24:27], v[40:43]
  ds_read_b64_tr_b16 a[6:7], v5 offset:4256
  v_mfma_f32_16x16x32_bf16 v[100:103], a[8:11], a[28:31], v[100:103]
  ds_read_b64_tr_b16 a[8:9], v5 offset:448
  ds_read_b64_tr_b16 a[10:11], v5 offset:4288
  s_waitcnt lgkmcnt(10)
  v_mfma_f32_16x16x32_bf16 v[44:47], a[12:15], a[24:27], v[44:47]
  ds_read_b128 a[32:35], v7 offset:10240
  v_mfma_f32_16x16x32_bf16 v[104:107], a[12:15], a[28:31], v[104:107]
  ds_read_b64_tr_b16 a[12:13], v5 offset:15360
  ds_read_b64_tr_b16 a[14:15], v5 offset:19200
  s_waitcnt lgkmcnt(11)
  v_mfma_f32_16x16x32_bf16 v[48:51], a[24:27], a[16:19], v[48:51]
  ds_read_b128 a[36:39], v7 offset:12288
  v_mfma_f32_16x16x32_bf16 v[108:111], a[28:31], a[16:19], v[108:111]
  ds_read_b64_tr_b16 a[16:17], v5 offset:15392
  ds_read_b64_tr_b16 a[18:19], v5 offset:19232
  s_waitcnt lgkmcnt(12)
  v_mfma_f32_16x16x32_bf16 v[52:55], a[24:27], a[20:23], v[52:55]
  ds_read_b128 a[44:47], v7
  v_mfma_f32_16x16x32_bf16 v[112:115], a[28:31], a[20:23], v[112:115]
  ds_read_b64_tr_b16 a[20:21], v5 offset:15424
  s_waitcnt lgkmcnt(12)
  v_mfma_f32_16x16x32_bf16 v[56:59], a[24:27], a[0:3], v[56:59]
  ds_read_b64_tr_b16 a[22:23], v5 offset:19264
  v_mfma_f32_16x16x32_bf16 v[116:119], a[28:31], a[0:3], v[116:119]
  v_mfma_f32_16x16x32_bf16 v[192:195], a[40:43], a[0:3], v[192:195]
  ds_read_b64_tr_b16 a[0:1], v5 offset:15456
  s_waitcnt lgkmcnt(12)
  v_mfma_f32_16x16x32_bf16 v[60:63], a[24:27], a[4:7], v[60:63]
  ds_read_b64_tr_b16 a[2:3], v5 offset:19296
  v_mfma_f32_16x16x32_bf16 v[120:123], a[28:31], a[4:7], v[120:123]
  ds_read_b64_tr_b16 a[4:5], v5 offset:15488
  s_waitcnt lgkmcnt(12)
  v_mfma_f32_16x16x32_bf16 v[64:67], a[24:27], a[8:11], v[64:67]
  ds_read_b64_tr_b16 a[6:7], v5 offset:19328
  v_mfma_f32_16x16x32_bf16 v[124:127], a[28:31], a[8:11], v[124:127]
  ds_read_b64_tr_b16 a[8:9], v5 offset:15520
  s_waitcnt lgkmcnt(11)
  v_mfma_f32_16x16x32_bf16 v[8:11], a[12:15], a[32:35], v[8:11]
  ds_read_b64_tr_b16 a[10:11], v5 offset:19360
  s_waitcnt lgkmcnt(11)
  v_mfma_f32_16x16x32_bf16 v[68:71], a[12:15], a[36:39], v[68:71]
  ds_read_b64_tr_b16 a[12:13], v5 offset:15552
  s_waitcnt lgkmcnt(10)
  v_mfma_f32_16x16x32_bf16 v[12:15], a[16:19], a[32:35], v[12:15]
  ds_read_b64_tr_b16 a[14:15], v5 offset:19392
  v_mfma_f32_16x16x32_bf16 v[72:75], a[16:19], a[36:39], v[72:75]
  ds_read_b64_tr_b16 a[16:17], v5 offset:15584
  s_waitcnt lgkmcnt(9)
  v_mfma_f32_16x16x32_bf16 v[16:19], a[20:23], a[32:35], v[16:19]
  ds_read_b64_tr_b16 a[18:19], v5 offset:19424
  v_mfma_f32_16x16x32_bf16 v[76:79], a[20:23], a[36:39], v[76:79]
  ds_read_b64_tr_b16 a[20:21], v5 offset:15616
  s_waitcnt lgkmcnt(9)
  v_mfma_f32_16x16x32_bf16 v[20:23], a[0:3], a[32:35], v[20:23]
  ds_read_b64_tr_b16 a[22:23], v5 offset:19456
  v_mfma_f32_16x16x32_bf16 v[80:83], a[0:3], a[36:39], v[80:83]
  ds_read_b64_tr_b16 a[0:1], v5 offset:15648
  s_waitcnt lgkmcnt(9)
  v_mfma_f32_16x16x32_bf16 v[24:27], a[4:7], a[32:35], v[24:27]
  ds_read_b64_tr_b16 a[2:3], v5 offset:19488
  v_mfma_f32_16x16x32_bf16 v[84:87], a[4:7], a[36:39], v[84:87]
  ds_read_b64_tr_b16 a[4:5], v5 offset:15680
  s_waitcnt lgkmcnt(9)
  v_mfma_f32_16x16x32_bf16 v[28:31], a[8:11], a[32:35], v[28:31]
  ds_read_b64_tr_b16 a[6:7], v5 offset:19520
  v_mfma_f32_16x16x32_bf16 v[88:91], a[8:11], a[36:39], v[88:91]
  ds_read_b64_tr_b16 a[8:9], v5 offset:15712
  s_waitcnt lgkmcnt(9)
  v_mfma_f32_16x16x32_bf16 v[32:35], a[12:15], a[32:35], v[32:35]
  ds_read_b64_tr_b16 a[10:11], v5 offset:19552
  v_mfma_f32_16x16x32_bf16 v[92:95], a[12:15], a[36:39], v[92:95]
  ds_read_b64_tr_b16 a[12:13], v5 offset:15744
  s_waitcnt lgkmcnt(9)
  v_mfma_f32_16x16x32_bf16 v[36:39], a[16:19], a[32:35], v[36:39]
  ds_read_b64_tr_b16 a[14:15], v5 offset:19584
  v_mfma_f32_16x16x32_bf16 v[96:99], a[16:19], a[36:39], v[96:99]
  v_mfma_f32_16x16x32_bf16 v[188:191], a[16:19], a[44:47], v[188:191]
  ds_read_b64_tr_b16 a[16:17], v5 offset:15776
  s_waitcnt lgkmcnt(9)
  v_mfma_f32_16x16x32_bf16 v[40:43], a[20:23], a[32:35], v[40:43]
  ds_read_b64_tr_b16 a[18:19], v5 offset:19616
  v_mfma_f32_16x16x32_bf16 v[100:103], a[20:23], a[36:39], v[100:103]
  ds_read_b64_tr_b16 a[20:21], v5 offset:15808
  ds_read_b64_tr_b16 a[22:23], v5 offset:19648
  s_waitcnt lgkmcnt(10)
  v_mfma_f32_16x16x32_bf16 v[44:47], a[0:3], a[32:35], v[44:47]
  s_add_u32 s47, s47, 49152
  s_cmp_eq_u32 s47, 147456
  v_mfma_f32_16x16x32_bf16 v[104:107], a[0:3], a[36:39], v[104:107]
  s_cselect_b32 s47, 0, s47
  v_add_u32 v5, s47, v2
  s_waitcnt lgkmcnt(8)
  v_mfma_f32_16x16x32_bf16 v[48:51], a[32:35], a[4:7], v[48:51]
  v_add_u32 v6, s47, v3
  v_add_u32 v7, s47, v4
  v_mfma_f32_16x16x32_bf16 v[108:111], a[36:39], a[4:7], v[108:111]
  s_sub_u32 s48, s48, 1
  s_waitcnt lgkmcnt(6)
  v_mfma_f32_16x16x32_bf16 v[52:55], a[32:35], a[8:11], v[52:55]
  v_mfma_f32_16x16x32_bf16 v[112:115], a[36:39], a[8:11], v[112:115]
  s_waitcnt lgkmcnt(0)
  s_barrier
  v_mfma_f32_16x16x32_bf16 v[56:59], a[32:35], a[12:15], v[56:59]
  ds_read_b128 a[24:27], v6 offset:10240
  ds_read_b64_tr_b16 a[0:1], v5 offset:0
  v_mfma_f32_16x16x32_bf16 v[116:119], a[36:39], a[12:15], v[116:119]
  ds_read_b64_tr_b16 a[2:3], v5 offset:3840
  v_mfma_f32_16x16x32_bf16 v[192:195], a[44:47], a[12:15], v[192:195]
  ds_read_b128 a[28:31], v6 offset:12288
  ds_read_b64_tr_b16 a[4:5], v5 offset:32
  v_mfma_f32_16x16x32_bf16 v[60:63], a[32:35], a[16:19], v[60:63]
  ds_read_b64_tr_b16 a[6:7], v5 offset:3872
  ds_read_b64_tr_b16 a[8:9], v5 offset:64
  v_mfma_f32_16x16x32_bf16 v[120:123], a[36:39], a[16:19], v[120:123]
  ds_read_b64_tr_b16 a[10:11], v5 offset:3904
  ds_read_b128 a[40:43], v6
  v_mfma_f32_16x16x32_bf16 v[64:67], a[32:35], a[20:23], v[64:67]
  ds_read_b64_tr_b16 a[12:13], v5 offset:96
  ds_read_b64_tr_b16 a[14:15], v5 offset:3936
  v_mfma_f32_16x16x32_bf16 v[124:127], a[36:39], a[20:23], v[124:127]
  s_cmp_lg_u32 s48, 0
  ds_read_b64_tr_b16 a[16:17], v5 offset:128
  ds_read_b64_tr_b16 a[18:19], v5 offset:3968
  ds_read_b64_tr_b16 a[20:21], v5 offset:160
  ds_read_b64_tr_b16 a[22:23], v5 offset:4000
  s_cbranch_scc1 QC2_LOOP
  v_lshlrev_b32 v5, 3, v1
  v_add_u32 v5, 49152, v5
  s_nop 7
  v_cvt_pk_bf16_f32 v188, v188, v189
  v_cvt_pk_bf16_f32 v189, v190, v191
  v_cvt_pk_bf16_f32 v192, v192, v193
  v_cvt_pk_bf16_f32 v193, v194, v195
  ds_write_b64 v5, v[188:189] offset:1024
  ds_write_b64 v5, v[192:193] offset:3584
  ds_write_b64 v5, v[188:189] offset:6144
  ds_write_b64 v5, v[192:193] offset:8704
  s_branch QC_EPI
QC3_ENT:
  s_mov_b32 s48, 10
  s_barrier
  ds_read_b128 a[24:27], v6 offset:14336
  ds_read_b64_tr_b16 a[0:1], v5 offset:0
  ds_read_b64_tr_b16 a[2:3], v5 offset:3840
  ds_read_b128 a[28:31], v6 offset:16384
  ds_read_b64_tr_b16 a[4:5], v5 offset:32
  ds_read_b64_tr_b16 a[6:7], v5 offset:3872
  ds_read_b64_tr_b16 a[8:9], v5 offset:64
  ds_read_b64_tr_b16 a[10:11], v5 offset:3904
  ds_read_b128 a[40:43], v6
  ds_read_b64_tr_b16 a[12:13], v5 offset:96
  ds_read_b64_tr_b16 a[14:15], v5 offset:3936
  ds_read_b64_tr_b16 a[16:17], v5 offset:128
  ds_read_b64_tr_b16 a[18:19], v5 offset:3968
  ds_read_b64_tr_b16 a[20:21], v5 offset:160
  ds_read_b64_tr_b16 a[22:23], v5 offset:4000
QC3_LOOP:
  s_waitcnt lgkmcnt(12)
  v_mfma_f32_16x16x32_bf16 v[8:11], a[0:3], a[24:27], v[8:11]
  s_waitcnt lgkmcnt(11)
  v_mfma_f32_16x16x32_bf16 v[68:71], a[0:3], a[28:31], v[68:71]
  ds_read_b64_tr_b16 a[0:1], v5 offset:192
  s_waitcnt lgkmcnt(10)
  v_mfma_f32_16x16x32_bf16 v[12:15], a[4:7], a[24:27], v[12:15]
  ds_read_b64_tr_b16 a[2:3], v5 offset:4032
  v_mfma_f32_16x16x32_bf16 v[72:75], a[4:7], a[28:31], v[72:75]
  ds_read_b64_tr_b16 a[4:5], v5 offset:224
  s_waitcnt lgkmcnt(10)
  v_mfma_f32_16x16x32_bf16 v[16:19], a[8:11], a[24:27], v[16:19]
  ds_read_b64_tr_b16 a[6:7], v5 offset:4064
  v_mfma_f32_16x16x32_bf16 v[76:79], a[8:11], a[28:31], v[76:79]
  ds_read_b64_tr_b16 a[8:9], v5 offset:256
  s_waitcnt lgkmcnt(9)
  v_mfma_f32_16x16x32_bf16 v[20:23], a[12:15], a[24:27], v[20:23]
  ds_read_b64_tr_b16 a[10:11], v5 offset:4096
  v_mfma_f32_16x16x32_bf16 v[80:83], a[12:15], a[28:31], v[80:83]
  ds_read_b64_tr_b16 a[12:13], v5 offset:288
  s_waitcnt lgkmcnt(9)
  v_mfma_f32_16x16x32_bf16 v[24:27], a[16:19], a[24:27], v[24:27]
  ds_read_b64_tr_b16 a[14:15], v5 offset:4128
  v_mfma_f32_16x16x32_bf16 v[84:87], a[16:19], a[28:31], v[84:87]
  ds_read_b64_tr_b16 a[16:17], v5 offset:320
  s_waitcnt lgkmcnt(9)
  v_mfma_f32_16x16x32_bf16 v[28:31], a[20:23], a[24:27], v[28:31]
  ds_read_b64_tr_b16 a[18:19], v5 offset:4160
  v_mfma_f32_16x16x32_bf16 v[88:91], a[20:23], a[28:31], v[88:91]
  ds_read_b64_tr_b16 a[20:21], v5 offset:352
  s_waitcnt lgkmcnt(9)
  v_mfma_f32_16x16x32_bf16 v[32:35], a[0:3], a[24:27], v[32:35]
  ds_read_b64_tr_b16 a[22:23], v5 offset:4192
  v_mfma_f32_16x16x32_bf16 v[92:95], a[0:3], a[28:31], v[92:95]
  ds_read_b64_tr_b16 a[0:1], v5 offset:384
  s_waitcnt lgkmcnt(9)
  v_mfma_f32_16x16x32_bf16 v[36:39], a[4:7], a[24:27], v[36:39]
  ds_read_b64_tr_b16 a[2:3], v5 offset:4224
  v_mfma_f32_16x16x32_bf16 v[96:99], a[4:7], a[28:31], v[96:99]
  ds_read_b64_tr_b16 a[4:5], v5 offset:416
  s_waitcnt lgkmcnt(9)
  v_mfma_f32_16x16x32_bf16 v[40:43], a[8:11], a[24:27], v[40:43]
  ds_read_b64_tr_b16 a[6:7], v5 offset:4256
  v_mfma_f32_16x16x32_bf16 v[100:103], a[8:11], a[28:31], v[100:103]
  v_mfma_f32_16x16x32_bf16 v[188:191], a[8:11], a[40:43], v[188:191]
  ds_read_b64_tr_b16 a[8:9], v5 offset:448
  ds_read_b64_tr_b16 a[10:11], v5 offset:4288
  s_waitcnt lgkmcnt(10)
  v_mfma_f32_16x16x32_bf16 v[44:47], a[12:15], a[24:27], v[44:47]
  ds_read_b128 a[32:35], v7 offset:14336
  v_mfma_f32_16x16x32_bf16 v[104:107], a[12:15], a[28:31], v[104:107]
  ds_read_b64_tr_b16 a[12:13], v5 offset:15360
  ds_read_b64_tr_b16 a[14:15], v5 offset:19200
  s_waitcnt lgkmcnt(11)
  v_mfma_f32_16x16x32_bf16 v[48:51], a[24:27], a[16:19], v[48:51]
  ds_read_b128 a[36:39], v7 offset:16384
  v_mfma_f32_16x16x32_bf16 v[108:111], a[28:31], a[16:19], v[108:111]
  ds_read_b64_tr_b16 a[16:17], v5 offset:15392
  ds_read_b64_tr_b16 a[18:19], v5 offset:19232
  s_waitcnt lgkmcnt(12)
  v_mfma_f32_16x16x32_bf16 v[52:55], a[24:27], a[20:23], v[52:55]
  ds_read_b128 a[44:47], v7
  v_mfma_f32_16x16x32_bf16 v[112:115], a[28:31], a[20:23], v[112:115]
  ds_read_b64_tr_b16 a[20:21], v5 offset:15424
  s_waitcnt lgkmcnt(12)
  v_mfma_f32_16x16x32_bf16 v[56:59], a[24:27], a[0:3], v[56:59]
  ds_read_b64_tr_b16 a[22:23], v5 offset:19264
  v_mfma_f32_16x16x32_bf16 v[116:119], a[28:31], a[0:3], v[116:119]
  ds_read_b64_tr_b16 a[0:1], v5 offset:15456
  s_waitcnt lgkmcnt(12)
  v_mfma_f32_16x16x32_bf16 v[60:63], a[24:27], a[4:7], v[60:63]
  ds_read_b64_tr_b16 a[2:3], v5 offset:19296
  v_mfma_f32_16x16x32_bf16 v[120:123], a[28:31], a[4:7], v[120:123]
  v_mfma_f32_16x16x32_bf16 v[192:195], a[40:43], a[4:7], v[192:195]
  ds_read_b64_tr_b16 a[4:5], v5 offset:15488
  s_waitcnt lgkmcnt(12)
  v_mfma_f32_16x16x32_bf16 v[64:67], a[24:27], a[8:11], v[64:67]
  ds_read_b64_tr_b16 a[6:7], v5 offset:19328
  v_mfma_f32_16x16x32_bf16 v[124:127], a[28:31], a[8:11], v[124:127]
  ds_read_b64_tr_b16 a[8:9], v5 offset:15520
  s_waitcnt lgkmcnt(11)
  v_mfma_f32_16x16x32_bf16 v[8:11], a[12:15], a[32:35], v[8:11]
  ds_read_b64_tr_b16 a[10:11], v5 offset:19360
  s_waitcnt lgkmcnt(11)
  v_mfma_f32_16x16x32_bf16 v[68:71], a[12:15], a[36:39], v[68:71]
  ds_read_b64_tr_b16 a[12:13], v5 offset:15552
  s_waitcnt lgkmcnt(10)
  v_mfma_f32_16x16x32_bf16 v[12:15], a[16:19], a[32:35], v[12:15]
  ds_read_b64_tr_b16 a[14:15], v5 offset:19392
  v_mfma_f32_16x16x32_bf16 v[72:75], a[16:19], a[36:39], v[72:75]
  ds_read_b64_tr_b16 a[16:17], v5 offset:15584
  s_waitcnt lgkmcnt(9)
  v_mfma_f32_16x16x32_bf16 v[16:19], a[20:23], a[32:35], v[16:19]
  ds_read_b64_tr_b16 a[18:19], v5 offset:19424
  v_mfma_f32_16x16x32_bf16 v[76:79], a[20:23], a[36:39], v[76:79]
  ds_read_b64_tr_b16 a[20:21], v5 offset:15616
  s_waitcnt lgkmcnt(9)
  v_mfma_f32_16x16x32_bf16 v[20:23], a[0:3], a[32:35], v[20:23]
  ds_read_b64_tr_b16 a[22:23], v5 offset:19456
  v_mfma_f32_16x16x32_bf16 v[80:83], a[0:3], a[36:39], v[80:83]
  ds_read_b64_tr_b16 a[0:1], v5 offset:15648
  s_waitcnt lgkmcnt(9)
  v_mfma_f32_16x16x32_bf16 v[24:27], a[4:7], a[32:35], v[24:27]
  ds_read_b64_tr_b16 a[2:3], v5 offset:19488
  v_mfma_f32_16x16x32_bf16 v[84:87], a[4:7], a[36:39], v[84:87]
  ds_read_b64_tr_b16 a[4:5], v5 offset:15680
  s_waitcnt lgkmcnt(9)
  v_mfma_f32_16x16x32_bf16 v[28:31], a[8:11], a[32:35], v[28:31]
  ds_read_b64_tr_b16 a[6:7], v5 offset:19520
  v_mfma_f32_16x16x32_bf16 v[88:91], a[8:11], a[36:39], v[88:91]
  ds_read_b64_tr_b16 a[8:9], v5 offset:15712
  s_waitcnt lgkmcnt(9)
  v_mfma_f32_16x16x32_bf16 v[32:35], a[12:15], a[32:35], v[32:35]
  ds_read_b64_tr_b16 a[10:11], v5 offset:19552
  v_mfma_f32_16x16x32_bf16 v[92:95], a[12:15], a[36:39], v[92:95]
  ds_read_b64_tr_b16 a[12:13], v5 offset:15744
  s_waitcnt lgkmcnt(9)
  v_mfma_f32_16x16x32_bf16 v[36:39], a[16:19], a[32:35], v[36:39]
  ds_read_b64_tr_b16 a[14:15], v5 offset:19584
  v_mfma_f32_16x16x32_bf16 v[96:99], a[16:19], a[36:39], v[96:99]
  ds_read_b64_tr_b16 a[16:17], v5 offset:15776
  s_waitcnt lgkmcnt(9)
  v_mfma_f32_16x16x32_bf16 v[40:43], a[20:23], a[32:35], v[40:43]
  ds_read_b64_tr_b16 a[18:19], v5 offset:19616
  v_mfma_f32_16x16x32_bf16 v[100:103], a[20:23], a[36:39], v[100:103]
  v_mfma_f32_16x16x32_bf16 v[188:191], a[20:23], a[44:47], v[188:191]
  ds_read_b64_tr_b16 a[20:21], v5 offset:15808
  ds_read_b64_tr_b16 a[22:23], v5 offset:19648
  s_waitcnt lgkmcnt(10)
  v_mfma_f32_16x16x32_bf16 v[44:47], a[0:3], a[32:35], v[44:47]
  s_add_u32 s47, s47, 49152
  s_cmp_eq_u32 s47, 147456
  v_mfma_f32_16x16x32_bf16 v[104:107], a[0:3], a[36:39], v[104:107]
  s_cselect_b32 s47, 0, s47
  v_add_u32 v5, s47, v2
  s_waitcnt lgkmcnt(8)
  v_mfma_f32_16x16x32_bf16 v[48:51], a[32:35], a[4:7], v[48:51]
  v_add_u32 v6, s47, v3
  v_add_u32 v7, s47, v4
  v_mfma_f32_16x16x32_bf16 v[108:111], a[36:39], a[4:7], v[108:111]
  s_sub_u32 s48, s48, 1
  s_waitcnt lgkmcnt(6)
  v_mfma_f32_16x16x32_bf16 v[52:55], a[32:35], a[8:11], v[52:55]
  v_mfma_f32_16x16x32_bf16 v[112:115], a[36:39], a[8:11], v[112:115]
  s_waitcnt lgkmcnt(0)
  s_barrier
  v_mfma_f32_16x16x32_bf16 v[56:59], a[32:35], a[12:15], v[56:59]
  ds_read_b128 a[24:27], v6 offset:14336
  ds_read_b64_tr_b16 a[0:1], v5 offset:0
  v_mfma_f32_16x16x32_bf16 v[116:119], a[36:39], a[12:15], v[116:119]
  ds_read_b64_tr_b16 a[2:3], v5 offset:3840
  ds_read_b128 a[28:31], v6 offset:16384
  v_mfma_f32_16x16x32_bf16 v[60:63], a[32:35], a[16:19], v[60:63]
  ds_read_b64_tr_b16 a[4:5], v5 offset:32
  ds_read_b64_tr_b16 a[6:7], v5 offset:3872
  v_mfma_f32_16x16x32_bf16 v[120:123], a[36:39], a[16:19], v[120:123]
  ds_read_b64_tr_b16 a[8:9], v5 offset:64
  v_mfma_f32_16x16x32_bf16 v[192:195], a[44:47], a[16:19], v[192:195]
  ds_read_b64_tr_b16 a[10:11], v5 offset:3904
  ds_read_b128 a[40:43], v6
  v_mfma_f32_16x16x32_bf16 v[64:67], a[32:35], a[20:23], v[64:67]
  ds_read_b64_tr_b16 a[12:13], v5 offset:96
  ds_read_b64_tr_b16 a[14:15], v5 offset:3936
  v_mfma_f32_16x16x32_bf16 v[124:127], a[36:39], a[20:23], v[124:127]
  s_cmp_lg_u32 s48, 0
  ds_read_b64_tr_b16 a[16:17], v5 offset:128
  ds_read_b64_tr_b16 a[18:19], v5 offset:3968
  ds_read_b64_tr_b16 a[20:21], v5 offset:160
  ds_read_b64_tr_b16 a[22:23], v5 offset:4000
  s_cbranch_scc1 QC3_LOOP
  v_lshlrev_b32 v5, 3, v1
  v_add_u32 v5, 49152, v5
  s_nop 7
  v_cvt_pk_bf16_f32 v188, v188, v189
  v_cvt_pk_bf16_f32 v189, v190, v191
  v_cvt_pk_bf16_f32 v192, v192, v193
  v_cvt_pk_bf16_f32 v193, v194, v195
  ds_write_b64 v5, v[188:189] offset:1536
  ds_write_b64 v5, v[192:193] offset:4096
  ds_write_b64 v5, v[188:189] offset:6656
  ds_write_b64 v5, v[192:193] offset:9216
QC_EPI:
  s_mul_i32 s60, s59, 10240
  s_add_u32 s60, s60, 49152
  v_lshl_add_u32 v6, v1, 3, s60
  v_add_u32 v5, 10240, v6
  v_lshlrev_b32 v7, 4, v1
  s_nop 4
  v_cvt_pk_bf16_f32 v160, v28, v29
  v_cvt_pk_bf16_f32 v161, v30, v31
  v_cvt_pk_bf16_f32 v162, v32, v33
  v_cvt_pk_bf16_f32 v163, v34, v35
  v_cvt_pk_bf16_f32 v164, v36, v37
  v_cvt_pk_bf16_f32 v165, v38, v39
  v_cvt_pk_bf16_f32 v166, v40, v41
  v_cvt_pk_bf16_f32 v167, v42, v43
  v_cvt_pk_bf16_f32 v168, v44, v45
  v_cvt_pk_bf16_f32 v169, v46, v47
  v_cvt_pk_bf16_f32 v28, v48, v49
  v_cvt_pk_bf16_f32 v29, v50, v51
  v_cvt_pk_bf16_f32 v32, v52, v53
  v_cvt_pk_bf16_f32 v33, v54, v55
  v_cvt_pk_bf16_f32 v36, v56, v57
  v_cvt_pk_bf16_f32 v37, v58, v59
  v_cvt_pk_bf16_f32 v40, v60, v61
  v_cvt_pk_bf16_f32 v41, v62, v63
  v_cvt_pk_bf16_f32 v44, v64, v65
  v_cvt_pk_bf16_f32 v45, v66, v67
  v_cvt_pk_bf16_f32 v48, v88, v89
  v_cvt_pk_bf16_f32 v49, v90, v91
  v_cvt_pk_bf16_f32 v50, v92, v93
  v_cvt_pk_bf16_f32 v51, v94, v95
  v_cvt_pk_bf16_f32 v52, v96, v97
  v_cvt_pk_bf16_f32 v53, v98, v99
  v_cvt_pk_bf16_f32 v54, v100, v101
  v_cvt_pk_bf16_f32 v55, v102, v103
  v_cvt_pk_bf16_f32 v56, v104, v105
  v_cvt_pk_bf16_f32 v57, v106, v107
  v_cvt_pk_bf16_f32 v88, v108, v109
  v_cvt_pk_bf16_f32 v89, v110, v111
  v_cvt_pk_bf16_f32 v92, v112, v113
  v_cvt_pk_bf16_f32 v93, v114, v115
  v_cvt_pk_bf16_f32 v96, v116, v117
  v_cvt_pk_bf16_f32 v97, v118, v119
  v_cvt_pk_bf16_f32 v100, v120, v121
  v_cvt_pk_bf16_f32 v101, v122, v123
  v_cvt_pk_bf16_f32 v104, v124, v125
  v_cvt_pk_bf16_f32 v105, v126, v127
  s_cmp_eq_u32 s59, 3
  s_cbranch_scc1 QC_NOW_2
  ds_write_b64 v5, v[160:161] offset:0
  ds_write_b64 v5, v[162:163] offset:512
  ds_write_b64 v5, v[164:165] offset:1024
  ds_write_b64 v5, v[166:167] offset:1536
  ds_write_b64 v5, v[168:169] offset:2048
  ds_write_b64 v5, v[28:29] offset:2560
  ds_write_b64 v5, v[32:33] offset:3072
  ds_write_b64 v5, v[36:37] offset:3584
  ds_write_b64 v5, v[40:41] offset:4096
  ds_write_b64 v5, v[44:45] offset:4608
  ds_write_b64 v5, v[48:49] offset:5120
  ds_write_b64 v5, v[50:51] offset:5632
  ds_write_b64 v5, v[52:53] offset:6144
  ds_write_b64 v5, v[54:55] offset:6656
  ds_write_b64 v5, v[56:57] offset:7168
  ds_write_b64 v5, v[88:89] offset:7680
  ds_write_b64 v5, v[92:93] offset:8192
  ds_write_b64 v5, v[96:97] offset:8704
  ds_write_b64 v5, v[100:101] offset:9216
  ds_write_b64 v5, v[104:105] offset:9728
QC_NOW_2:
  s_mov_b64 exec, -1
  v_cvt_pk_bf16_f32 v128, v8, v9
  v_cvt_pk_bf16_f32 v129, v10, v11
  v_cvt_pk_bf16_f32 v144, v68, v69
  v_cvt_pk_bf16_f32 v145, v70, v71
  s_mov_b64 exec, s[66:67]
  v_cvt_pk_bf16_f32 v132, v12, v13
  v_cvt_pk_bf16_f32 v133, v14, v15
  v_cvt_pk_bf16_f32 v148, v72, v73
  v_cvt_pk_bf16_f32 v149, v74, v75
  s_mov_b64 exec, s[72:73]
  v_cvt_pk_bf16_f32 v130, v12, v13
  v_cvt_pk_bf16_f32 v131, v14, v15
  v_cvt_pk_bf16_f32 v146, v72, v73
  v_cvt_pk_bf16_f32 v147, v74, v75
  s_mov_b64 exec, s[68:69]
  v_cvt_pk_bf16_f32 v136, v16, v17
  v_cvt_pk_bf16_f32 v137, v18, v19
  v_cvt_pk_bf16_f32 v152, v76, v77
  v_cvt_pk_bf16_f32 v153, v78, v79
  s_mov_b64 exec, s[74:75]
  v_cvt_pk_bf16_f32 v134, v16, v17
  v_cvt_pk_bf16_f32 v135, v18, v19
  v_cvt_pk_bf16_f32 v150, v76, v77
  v_cvt_pk_bf16_f32 v151, v78, v79
  s_mov_b64 exec, s[70:71]
  v_cvt_pk_bf16_f32 v140, v20, v21
  v_cvt_pk_bf16_f32 v141, v22, v23
  v_cvt_pk_bf16_f32 v156, v80, v81
  v_cvt_pk_bf16_f32 v157, v82, v83
  s_mov_b64 exec, s[76:77]
  v_cvt_pk_bf16_f32 v138, v20, v21
  v_cvt_pk_bf16_f32 v139, v22, v23
  v_cvt_pk_bf16_f32 v154, v80, v81
  v_cvt_pk_bf16_f32 v155, v82, v83
  s_mov_b64 exec, -1
  v_cvt_pk_bf16_f32 v142, v24, v25
  v_cvt_pk_bf16_f32 v143, v26, v27
  v_cvt_pk_bf16_f32 v158, v84, v85
  v_cvt_pk_bf16_f32 v159, v86, v87
  s_mov_b64 exec, -1
  s_nop 1
  v_mfma_f32_16x16x32_bf16 v[8:11], v[160:163], v[128:131], v[170:173]
  v_mfma_f32_16x16x32_bf16 v[12:15], v[162:165], v[132:135], v[170:173]
  v_mfma_f32_16x16x32_bf16 v[16:19], v[164:167], v[136:139], v[170:173]
  v_mfma_f32_16x16x32_bf16 v[20:23], v[166:169], v[140:143], v[170:173]
  v_mfma_f32_16x16x32_bf16 v[24:27], v[48:51], v[144:147], v[170:173]
  v_mfma_f32_16x16x32_bf16 v[84:87], v[50:53], v[148:151], v[170:173]
  v_mfma_f32_16x16x32_bf16 v[58:61], v[52:55], v[152:155], v[170:173]
  v_mfma_f32_16x16x32_bf16 v[62:65], v[54:57], v[156:159], v[170:173]
  s_waitcnt lgkmcnt(0)
  s_barrier
  ds_read_b64 v[108:109], v6 offset:0
  ds_read_b64 v[110:111], v6 offset:512
  ds_read_b64 v[112:113], v6 offset:1024
  ds_read_b64 v[114:115], v6 offset:1536
  ds_read_b64 v[116:117], v6 offset:2048
  ds_read_b64 v[118:119], v6 offset:5120
  ds_read_b64 v[120:121], v6 offset:5632
  ds_read_b64 v[122:123], v6 offset:6144
  ds_read_b64 v[124:125], v6 offset:6656
  ds_read_b64 v[126:127], v6 offset:7168
  ds_read_b64 v[30:31], v6 offset:2560
  ds_read_b64 v[34:35], v6 offset:3072
  ds_read_b64 v[38:39], v6 offset:3584
  ds_read_b64 v[42:43], v6 offset:4096
  ds_read_b64 v[46:47], v6 offset:4608
  s_waitcnt lgkmcnt(10)
  ds_read_b64 v[90:91], v6 offset:7680
  ds_read_b64 v[94:95], v6 offset:8192
  ds_read_b64 v[98:99], v6 offset:8704
  ds_read_b64 v[102:103], v6 offset:9216
  ds_read_b64 v[106:107], v6 offset:9728
  v_mfma_f32_16x16x32_bf16 v[68:71], v[108:111], v[128:131], v[174:177]
  v_mfma_f32_16x16x32_bf16 v[72:75], v[110:113], v[132:135], v[174:177]
  v_mfma_f32_16x16x32_bf16 v[76:79], v[112:115], v[136:139], v[174:177]
  v_mfma_f32_16x16x32_bf16 v[80:83], v[114:117], v[140:143], v[174:177]
  s_waitcnt lgkmcnt(10)
  v_mfma_f32_16x16x32_bf16 v[188:191], v[118:121], v[144:147], v[178:181]
  v_mfma_f32_16x16x32_bf16 v[192:195], v[120:123], v[148:151], v[178:181]
  v_mfma_f32_16x16x32_bf16 v[196:199], v[122:125], v[152:155], v[178:181]
  v_mfma_f32_16x16x32_bf16 v[200:203], v[124:127], v[156:159], v[178:181]
  s_nop 7
  v_max_f32 v8, v8, v68
  v_max_f32 v9, v9, v69
  v_max_f32 v10, v10, v70
  v_max_f32 v11, v11, v71
  v_max_f32 v12, v12, v72
  v_max_f32 v13, v13, v73
  v_max_f32 v14, v14, v74
  v_max_f32 v15, v15, v75
  v_max_f32 v16, v16, v76
  v_max_f32 v17, v17, v77
  v_max_f32 v18, v18, v78
  v_max_f32 v19, v19, v79
  v_max_f32 v20, v20, v80
  v_max_f32 v21, v21, v81
  v_max_f32 v22, v22, v82
  v_max_f32 v23, v23, v83
  v_max_f32 v24, v24, v188
  v_max_f32 v25, v25, v189
  v_max_f32 v26, v26, v190
  v_max_f32 v27, v27, v191
  v_max_f32 v84, v84, v192
  v_max_f32 v85, v85, v193
  v_max_f32 v86, v86, v194
  v_max_f32 v87, v87, v195
  v_max_f32 v58, v58, v196
  v_max_f32 v59, v59, v197
  v_max_f32 v60, v60, v198
  v_max_f32 v61, v61, v199
  v_max_f32 v62, v62, v200
  v_max_f32 v63, v63, v201
  v_max_f32 v64, v64, v202
  v_max_f32 v65, v65, v203
  v_max3_f32 v160, v8, v9, v10
  v_max3_f32 v161, v12, v13, v14
  v_max3_f32 v162, v16, v17, v18
  v_max3_f32 v163, v20, v21, v22
  v_max3_f32 v164, v24, v25, v26
  v_max3_f32 v165, v84, v85, v86
  v_max3_f32 v166, v58, v59, v60
  v_max3_f32 v167, v62, v63, v64
  v_max_f32 v160, v160, v11
  v_max_f32 v161, v161, v15
  v_max_f32 v162, v162, v19
  v_max_f32 v163, v163, v23
  v_max_f32 v164, v164, v27
  v_max_f32 v165, v165, v87
  v_max_f32 v166, v166, v61
  v_max_f32 v167, v167, v65
  s_nop 1
  v_permlane32_swap_b32 v160, v161
  v_permlane32_swap_b32 v162, v163
  v_permlane32_swap_b32 v164, v165
  v_permlane32_swap_b32 v166, v167
  s_nop 0
  v_max_f32 v160, v160, v161
  v_max_f32 v162, v162, v163
  v_max_f32 v164, v164, v165
  v_max_f32 v166, v166, v167
  s_nop 1
  v_permlane16_swap_b32 v160, v162
  v_permlane16_swap_b32 v164, v166
  s_nop 1
  v_max_f32 v160, v160, v162
  v_max_f32 v164, v164, v166
  s_mov_b32 s60, 0x3ea52b5c
  v_mul_f32 v160, s60, v160
  v_mul_f32 v164, s60, v164
  v_mov_b32 v162, v160
  v_mov_b32 v166, v164
  s_nop 1
  v_permlane16_swap_b32 v160, v162
  v_permlane16_swap_b32 v164, v166
  s_nop 1
  v_mov_b32 v161, v160
  v_mov_b32 v163, v162
  v_mov_b32 v165, v164
  v_mov_b32 v167, v166
  s_nop 1
  v_permlane32_swap_b32 v160, v161
  v_permlane32_swap_b32 v162, v163
  v_permlane32_swap_b32 v164, v165
  v_permlane32_swap_b32 v166, v167
  s_nop 1
  v_fma_f32 v8, v8, s60, -v160
  v_fma_f32 v9, v9, s60, -v160
  v_fma_f32 v10, v10, s60, -v160
  v_fma_f32 v11, v11, s60, -v160
  v_fma_f32 v12, v12, s60, -v161
  v_fma_f32 v13, v13, s60, -v161
  v_fma_f32 v14, v14, s60, -v161
  v_fma_f32 v15, v15, s60, -v161
  v_fma_f32 v16, v16, s60, -v162
  v_fma_f32 v17, v17, s60, -v162
  v_fma_f32 v18, v18, s60, -v162
  v_fma_f32 v19, v19, s60, -v162
  v_fma_f32 v20, v20, s60, -v163
  v_fma_f32 v21, v21, s60, -v163
  v_fma_f32 v22, v22, s60, -v163
  v_fma_f32 v23, v23, s60, -v163
  v_fma_f32 v24, v24, s60, -v164
  v_fma_f32 v25, v25, s60, -v164
  v_fma_f32 v26, v26, s60, -v164
  v_fma_f32 v27, v27, s60, -v164
  v_fma_f32 v84, v84, s60, -v165
  v_fma_f32 v85, v85, s60, -v165
  v_fma_f32 v86, v86, s60, -v165
  v_fma_f32 v87, v87, s60, -v165
  v_fma_f32 v58, v58, s60, -v166
  v_fma_f32 v59, v59, s60, -v166
  v_fma_f32 v60, v60, s60, -v166
  v_fma_f32 v61, v61, s60, -v166
  v_fma_f32 v62, v62, s60, -v167
  v_fma_f32 v63, v63, s60, -v167
  v_fma_f32 v64, v64, s60, -v167
  v_fma_f32 v65, v65, s60, -v167
  v_exp_f32 v8, v8
  v_exp_f32 v9, v9
  v_exp_f32 v10, v10
  v_exp_f32 v11, v11
  v_exp_f32 v12, v12
  v_exp_f32 v13, v13
  v_exp_f32 v14, v14
  v_exp_f32 v15, v15
  v_exp_f32 v16, v16
  v_exp_f32 v17, v17
  v_exp_f32 v18, v18
  v_exp_f32 v19, v19
  v_exp_f32 v20, v20
  v_exp_f32 v21, v21
  v_exp_f32 v22, v22
  v_exp_f32 v23, v23
  v_exp_f32 v24, v24
  v_exp_f32 v25, v25
  v_exp_f32 v26, v26
  v_exp_f32 v27, v27
  v_exp_f32 v84, v84
  v_exp_f32 v85, v85
  v_exp_f32 v86, v86
  v_exp_f32 v87, v87
  v_exp_f32 v58, v58
  v_exp_f32 v59, v59
  v_exp_f32 v60, v60
  v_exp_f32 v61, v61
  v_exp_f32 v62, v62
  v_exp_f32 v63, v63
  v_exp_f32 v64, v64
  v_exp_f32 v65, v65
  v_cvt_pk_bf16_f32 v8, v8, v9
  v_cvt_pk_bf16_f32 v9, v10, v11
  v_cvt_pk_bf16_f32 v12, v12, v13
  v_cvt_pk_bf16_f32 v13, v14, v15
  v_cvt_pk_bf16_f32 v16, v16, v17
  v_cvt_pk_bf16_f32 v17, v18, v19
  v_cvt_pk_bf16_f32 v20, v20, v21
  v_cvt_pk_bf16_f32 v21, v22, v23
  v_cvt_pk_bf16_f32 v24, v24, v25
  v_cvt_pk_bf16_f32 v25, v26, v27
  v_cvt_pk_bf16_f32 v84, v84, v85
  v_cvt_pk_bf16_f32 v85, v86, v87
  v_cvt_pk_bf16_f32 v58, v58, v59
  v_cvt_pk_bf16_f32 v59, v60, v61
  v_cvt_pk_bf16_f32 v62, v62, v63
  v_cvt_pk_bf16_f32 v63, v64, v65
  v_and_b32 v68, v8, v182
  v_bfi_b32 v70, v182, 0, v8
  v_and_b32 v69, v9, v183
  v_bfi_b32 v71, v183, 0, v9
  v_and_b32 v72, v12, v182
  v_bfi_b32 v74, v182, 0, v12
  v_and_b32 v73, v13, v183
  v_bfi_b32 v75, v183, 0, v13
  v_and_b32 v76, v16, v182
  v_bfi_b32 v78, v182, 0, v16
  v_and_b32 v77, v17, v183
  v_bfi_b32 v79, v183, 0, v17
  v_and_b32 v80, v20, v182
  v_bfi_b32 v82, v182, 0, v20
  v_and_b32 v81, v21, v183
  v_bfi_b32 v83, v183, 0, v21
  v_and_b32 v188, v24, v182
  v_bfi_b32 v190, v182, 0, v24
  v_and_b32 v189, v25, v183
  v_bfi_b32 v191, v183, 0, v25
  v_and_b32 v192, v84, v182
  v_bfi_b32 v194, v182, 0, v84
  v_and_b32 v193, v85, v183
  v_bfi_b32 v195, v183, 0, v85
  v_and_b32 v196, v58, v182
  v_bfi_b32 v198, v182, 0, v58
  v_and_b32 v197, v59, v183
  v_bfi_b32 v199, v183, 0, v59
  v_and_b32 v200, v62, v182
  v_bfi_b32 v202, v182, 0, v62
  v_and_b32 v201, v63, v183
  v_bfi_b32 v203, v183, 0, v63
  s_waitcnt lgkmcnt(0)
  s_nop 0
  v_mfma_f32_16x16x32_bf16 v[8:11], v[184:187], v[68:71], 0
  v_mfma_f32_16x16x32_bf16 v[12:15], v[184:187], v[72:75], 0
  v_mfma_f32_16x16x32_bf16 v[16:19], v[184:187], v[76:79], 0
  v_mfma_f32_16x16x32_bf16 v[20:23], v[184:187], v[80:83], 0
  v_mfma_f32_16x16x32_bf16 v[24:27], v[184:187], v[188:191], 0
  v_mfma_f32_16x16x32_bf16 v[84:87], v[184:187], v[192:195], 0
  v_mfma_f32_16x16x32_bf16 v[58:61], v[184:187], v[196:199], 0
  v_mfma_f32_16x16x32_bf16 v[62:65], v[184:187], v[200:203], 0
  v_mfma_f32_16x16x32_bf16 v[128:131], v[28:31], v[68:71], 0
  v_mfma_f32_16x16x32_bf16 v[132:135], v[32:35], v[72:75], 0
  v_mfma_f32_16x16x32_bf16 v[144:147], v[32:35], v[68:71], 0
  v_mfma_f32_16x16x32_bf16 v[136:139], v[36:39], v[76:79], 0
  v_mfma_f32_16x16x32_bf16 v[148:151], v[36:39], v[72:75], 0
  v_mfma_f32_16x16x32_bf16 v[140:143], v[40:43], v[80:83], 0
  v_mfma_f32_16x16x32_bf16 v[152:155], v[40:43], v[76:79], 0
  v_mfma_f32_16x16x32_bf16 v[156:159], v[44:47], v[80:83], 0
  v_mfma_f32_16x16x32_bf16 v[108:111], v[88:91], v[188:191], 0
  v_mfma_f32_16x16x32_bf16 v[112:115], v[92:95], v[192:195], 0
  v_mfma_f32_16x16x32_bf16 v[124:127], v[92:95], v[188:191], 0
  v_mfma_f32_16x16x32_bf16 v[116:119], v[96:99], v[196:199], 0
  v_mfma_f32_16x16x32_bf16 v[160:163], v[96:99], v[192:195], 0
  v_mfma_f32_16x16x32_bf16 v[120:123], v[100:103], v[200:203], 0
  v_mfma_f32_16x16x32_bf16 v[164:167], v[100:103], v[196:199], 0
  v_mfma_f32_16x16x32_bf16 v[204:207], v[104:107], v[200:203], 0
  v_rcp_f32 v8, v8
  v_rcp_f32 v12, v12
  v_rcp_f32 v16, v16
  v_rcp_f32 v20, v20
  v_rcp_f32 v24, v24
  v_rcp_f32 v84, v84
  v_rcp_f32 v58, v58
  v_rcp_f32 v62, v62
  s_nop 4
  s_mov_b64 exec, -1
  v_mul_f32 v128, v128, v8
  v_mul_f32 v129, v129, v8
  v_mul_f32 v130, v130, v8
  v_mul_f32 v131, v131, v8
  v_mul_f32 v108, v108, v24
  v_mul_f32 v109, v109, v24
  v_mul_f32 v110, v110, v24
  v_mul_f32 v111, v111, v24
  s_mov_b64 exec, s[66:67]
  v_mul_f32 v132, v132, v12
  v_mul_f32 v133, v133, v12
  v_mul_f32 v134, v134, v12
  v_mul_f32 v135, v135, v12
  v_mul_f32 v112, v112, v84
  v_mul_f32 v113, v113, v84
  v_mul_f32 v114, v114, v84
  v_mul_f32 v115, v115, v84
  s_mov_b64 exec, s[72:73]
  v_mul_f32 v132, v144, v8
  v_mul_f32 v133, v145, v8
  v_mul_f32 v134, v146, v8
  v_mul_f32 v135, v147, v8
  v_mul_f32 v112, v124, v24
  v_mul_f32 v113, v125, v24
  v_mul_f32 v114, v126, v24
  v_mul_f32 v115, v127, v24
  s_mov_b64 exec, s[68:69]
  v_mul_f32 v136, v136, v16
  v_mul_f32 v137, v137, v16
  v_mul_f32 v138, v138, v16
  v_mul_f32 v139, v139, v16
  v_mul_f32 v116, v116, v58
  v_mul_f32 v117, v117, v58
  v_mul_f32 v118, v118, v58
  v_mul_f32 v119, v119, v58
  s_mov_b64 exec, s[74:75]
  v_mul_f32 v136, v148, v12
  v_mul_f32 v137, v149, v12
  v_mul_f32 v138, v150, v12
  v_mul_f32 v139, v151, v12
  v_mul_f32 v116, v160, v84
  v_mul_f32 v117, v161, v84
  v_mul_f32 v118, v162, v84
  v_mul_f32 v119, v163, v84
  s_mov_b64 exec, s[70:71]
  v_mul_f32 v140, v140, v20
  v_mul_f32 v141, v141, v20
  v_mul_f32 v142, v142, v20
  v_mul_f32 v143, v143, v20
  v_mul_f32 v120, v120, v62
  v_mul_f32 v121, v121, v62
  v_mul_f32 v122, v122, v62
  v_mul_f32 v123, v123, v62
  s_mov_b64 exec, s[76:77]
  v_mul_f32 v140, v152, v16
  v_mul_f32 v141, v153, v16
  v_mul_f32 v142, v154, v16
  v_mul_f32 v143, v155, v16
  v_mul_f32 v120, v164, v58
  v_mul_f32 v121, v165, v58
  v_mul_f32 v122, v166, v58
  v_mul_f32 v123, v167, v58
  s_mov_b64 exec, -1
  v_mul_f32 v156, v156, v20
  v_mul_f32 v157, v157, v20
  v_mul_f32 v158, v158, v20
  v_mul_f32 v159, v159, v20
  v_mul_f32 v204, v204, v62
  v_mul_f32 v205, v205, v62
  v_mul_f32 v206, v206, v62
  v_mul_f32 v207, v207, v62
  s_mov_b64 exec, -1
  v_and_b32 v6, 32, v1
  v_and_b32 v8, 15, v1
  v_lshl_or_b32 v6, v8, 1, v6
  v_bfe_u32 v8, v1, 4, 1
  v_or_b32 v6, v6, v8
  v_lshlrev_b32 v6, 3, v6
  s_and_b32 s60, s55, 1
  s_cmp_eq_u32 s60, 1
  s_cbranch_scc1 QC_ODD_3
  v_cvt_pk_bf16_f32 v128, v128, v129
  v_cvt_pk_bf16_f32 v129, v130, v131
  v_cvt_pk_bf16_f32 v130, v132, v133
  v_cvt_pk_bf16_f32 v131, v134, v135
  buffer_store_dwordx4 v[128:131], v7, s[24:27], s36 offen offset:0 sc1
  v_cvt_pk_bf16_f32 v136, v136, v137
  v_cvt_pk_bf16_f32 v137, v138, v139
  v_cvt_pk_bf16_f32 v138, v140, v141
  v_cvt_pk_bf16_f32 v139, v142, v143
  buffer_store_dwordx4 v[136:139], v7, s[24:27], s37 offen offset:0 sc1
  v_cvt_pk_bf16_f32 v156, v156, v157
  v_cvt_pk_bf16_f32 v157, v158, v159
  buffer_store_dwordx2 v[156:157], v6, s[24:27], s38 offen offset:0 sc1
  v_cvt_pk_bf16_f32 v108, v108, v109
  v_cvt_pk_bf16_f32 v109, v110, v111
  v_cvt_pk_bf16_f32 v110, v112, v113
  v_cvt_pk_bf16_f32 v111, v114, v115
  buffer_store_dwordx4 v[108:111], v7, s[24:27], s36 offen offset:1024 sc1
  v_cvt_pk_bf16_f32 v116, v116, v117
  v_cvt_pk_bf16_f32 v117, v118, v119
  v_cvt_pk_bf16_f32 v118, v120, v121
  v_cvt_pk_bf16_f32 v119, v122, v123
  buffer_store_dwordx4 v[116:119], v7, s[24:27], s37 offen offset:1024 sc1
  v_cvt_pk_bf16_f32 v204, v204, v205
  v_cvt_pk_bf16_f32 v205, v206, v207
  buffer_store_dwordx2 v[204:205], v6, s[24:27], s38 offen offset:1024 sc1
  s_branch QC_DONE_4
QC_ODD_3:
  v_cvt_pk_bf16_f32 v132, v132, v133
  v_cvt_pk_bf16_f32 v133, v134, v135
  v_cvt_pk_bf16_f32 v134, v136, v137
  v_cvt_pk_bf16_f32 v135, v138, v139
  buffer_store_dwordx4 v[132:135], v7, s[24:27], s37 offen offset:0 sc1
  v_cvt_pk_bf16_f32 v140, v140, v141
  v_cvt_pk_bf16_f32 v141, v142, v143
  v_cvt_pk_bf16_f32 v142, v156, v157
  v_cvt_pk_bf16_f32 v143, v158, v159
  buffer_store_dwordx4 v[140:143], v7, s[24:27], s38 offen offset:0 sc1
  v_cvt_pk_bf16_f32 v128, v128, v129
  v_cvt_pk_bf16_f32 v129, v130, v131
  buffer_store_dwordx2 v[128:129], v6, s[24:27], s36 offen offset:512 sc1
  v_cvt_pk_bf16_f32 v112, v112, v113
  v_cvt_pk_bf16_f32 v113, v114, v115
  v_cvt_pk_bf16_f32 v114, v116, v117
  v_cvt_pk_bf16_f32 v115, v118, v119
  buffer_store_dwordx4 v[112:115], v7, s[24:27], s37 offen offset:1024 sc1
  v_cvt_pk_bf16_f32 v120, v120, v121
  v_cvt_pk_bf16_f32 v121, v122, v123
  v_cvt_pk_bf16_f32 v122, v204, v205
  v_cvt_pk_bf16_f32 v123, v206, v207
  buffer_store_dwordx4 v[120:123], v7, s[24:27], s38 offen offset:1024 sc1
  v_cvt_pk_bf16_f32 v108, v108, v109
  v_cvt_pk_bf16_f32 v109, v110, v111
  buffer_store_dwordx2 v[108:109], v6, s[24:27], s36 offen offset:1536 sc1
QC_DONE_4:
  s_endpgm
K1_QL:
  s_setprio 3
  v_lshrrev_b32 v2, 3, v1
  v_lshrrev_b32 v3, 4, v1
  v_and_b32 v4, 7, v1
  s_lshl_b32 s60, s59, 5
  s_add_u32 s60, s60, s58
  s_mul_i32 s60, s60, 1280
  v_mul_u32_u24 v2, 2560, v2
  v_add_u32 v2, s60, v2
  v_xor_b32 v16, v3, v4
  v_lshl_add_u32 v16, v16, 4, v2
  v_or_b32 v17, 4, v3
  v_xor_b32 v17, v17, v4
  v_lshl_add_u32 v17, v17, 4, v2
  v_add_u32 v17, 20480, v17
  v_xor_b32 v18, v3, v4
  v_lshl_add_u32 v18, v18, 4, v2
  v_add_u32 v18, 1280, v18
  v_or_b32 v19, 4, v3
  v_xor_b32 v19, v19, v4
  v_lshl_add_u32 v19, v19, 4, v2
  v_add_u32 v19, 21760, v19
  s_mul_i32 s61, s55, 160
  s_lshl_b32 s60, s59, 8
  s_add_u32 s60, s60, 0
  v_add_u32 v2, s60, v1
  v_mul_u32_u24 v3, 2185, v2
  v_lshrrev_b32 v3, 16, v3
  v_mul_u32_u24 v4, 30, v3
  v_sub_u32 v4, v2, v4
  v_mul_u32_u24 v5, 205, v4
  v_lshrrev_b32 v5, 11, v5
  v_and_b32 v6, 0x13, v3
  v_and_b32 v7, 4, v3
  v_lshl_or_b32 v6, v7, 1, v6
  v_bfe_u32 v7, v3, 3, 1
  v_lshl_or_b32 v6, v7, 2, v6
  v_mul_u32_u24 v6, 3840, v6
  v_mul_u32_u24 v5, 1120, v5
  v_lshl_add_u32 v6, v4, 4, v6
  v_add_u32 v6, v6, v5
  v_add_u32 v10, s61, v6
  s_lshl_b32 s60, s59, 8
  s_add_u32 s60, s60, 64
  v_add_u32 v2, s60, v1
  v_mul_u32_u24 v3, 2185, v2
  v_lshrrev_b32 v3, 16, v3
  v_mul_u32_u24 v4, 30, v3
  v_sub_u32 v4, v2, v4
  v_mul_u32_u24 v5, 205, v4
  v_lshrrev_b32 v5, 11, v5
  v_and_b32 v6, 0x13, v3
  v_and_b32 v7, 4, v3
  v_lshl_or_b32 v6, v7, 1, v6
  v_bfe_u32 v7, v3, 3, 1
  v_lshl_or_b32 v6, v7, 2, v6
  v_mul_u32_u24 v6, 3840, v6
  v_mul_u32_u24 v5, 1120, v5
  v_lshl_add_u32 v6, v4, 4, v6
  v_add_u32 v6, v6, v5
  v_add_u32 v11, s61, v6
  s_lshl_b32 s60, s59, 8
  s_add_u32 s60, s60, 128
  v_add_u32 v2, s60, v1
  v_mul_u32_u24 v3, 2185, v2
  v_lshrrev_b32 v3, 16, v3
  v_mul_u32_u24 v4, 30, v3
  v_sub_u32 v4, v2, v4
  v_mul_u32_u24 v5, 205, v4
  v_lshrrev_b32 v5, 11, v5
  v_and_b32 v6, 0x13, v3
  v_and_b32 v7, 4, v3
  v_lshl_or_b32 v6, v7, 1, v6
  v_bfe_u32 v7, v3, 3, 1
  v_lshl_or_b32 v6, v7, 2, v6
  v_mul_u32_u24 v6, 3840, v6
  v_mul_u32_u24 v5, 1120, v5
  v_lshl_add_u32 v6, v4, 4, v6
  v_add_u32 v6, v6, v5
  v_add_u32 v12, s61, v6
  s_cmp_eq_u32 s59, 3
  s_cbranch_scc1 QL_H_5
  s_lshl_b32 s60, s59, 8
  s_add_u32 s60, s60, 192
  v_add_u32 v2, s60, v1
  v_mul_u32_u24 v3, 2185, v2
  v_lshrrev_b32 v3, 16, v3
  v_mul_u32_u24 v4, 30, v3
  v_sub_u32 v4, v2, v4
  v_mul_u32_u24 v5, 205, v4
  v_lshrrev_b32 v5, 11, v5
  v_and_b32 v6, 0x13, v3
  v_and_b32 v7, 4, v3
  v_lshl_or_b32 v6, v7, 1, v6
  v_bfe_u32 v7, v3, 3, 1
  v_lshl_or_b32 v6, v7, 2, v6
  v_mul_u32_u24 v6, 3840, v6
  v_mul_u32_u24 v5, 1120, v5
  v_lshl_add_u32 v6, v4, 4, v6
  v_add_u32 v6, v6, v5
  v_add_u32 v13, s61, v6
  v_mov_b32 v14, v13
  s_branch QL_HD_6
QL_H_5:
  v_lshrrev_b32 v2, 3, v1
  v_lshlrev_b32 v2, 1, v2
  s_sub_u32 s60, s58, 16
  v_add_u32 v2, s60, v2
  v_lshrrev_b32 v3, 4, v1
  v_and_b32 v4, 7, v1
  v_add_u32 v5, 0, v2
  v_max_i32 v5, 0, v5
  v_mul_u32_u24 v5, 1280, v5
  v_or_b32 v6, 0, v3
  v_xor_b32 v6, v6, v4
  v_lshl_add_u32 v13, v6, 4, v5
  v_add_u32 v5, 1, v2
  v_max_i32 v5, 0, v5
  v_mul_u32_u24 v5, 1280, v5
  v_or_b32 v6, 4, v3
  v_xor_b32 v6, v6, v4
  v_lshl_add_u32 v14, v6, 4, v5
QL_HD_6:
  s_waitcnt lgkmcnt(0)
  s_mov_b32 s24, s6
  s_and_b32 s25, s7, 0xffff
  s_mov_b32 s26, 2457600
  s_mov_b32 s27, 0x00020000
  s_mov_b32 s28, s4
  s_and_b32 s29, s5, 0xffff
  s_mov_b32 s30, 2621440
  s_mov_b32 s31, 0x00020000
  s_cmp_eq_u32 s59, 3
  s_cselect_b32 s32, s28, s24
  s_cselect_b32 s33, s29, s25
  s_cselect_b32 s34, s30, s26
  s_cselect_b32 s35, s31, s27
  s_lshl_b32 s45, s59, 12
  s_add_u32 s46, s45, 32768
  s_add_u32 s43, s45, 3072
  s_add_u32 s44, s45, 18432
  s_cmp_eq_u32 s59, 3
  s_cselect_b32 s43, 30720, s43
  s_cselect_b32 s44, 31744, s44
  s_mov_b32 s41, 0
  s_mul_i32 s36, s42, 245760
  s_add_u32 s37, s36, 122880
  s_lshl_b32 s38, s42, 7
  s_cmp_eq_u32 s59, 3
  s_cselect_b32 s39, s38, s36
  s_cselect_b32 s40, s38, s37
  s_add_u32 s49, s41, s46
  s_add_u32 m0, s49, 0
  s_nop 0
  buffer_load_dwordx4 v16, s[28:31], s38 offen lds
  s_add_u32 m0, s49, 1024
  s_nop 0
  buffer_load_dwordx4 v17, s[28:31], s38 offen lds
  s_add_u32 m0, s49, 2048
  s_nop 0
  buffer_load_dwordx4 v18, s[28:31], s38 offen lds
  s_add_u32 m0, s49, 3072
  s_nop 0
  buffer_load_dwordx4 v19, s[28:31], s38 offen lds
  s_add_u32 s49, s41, s45
  s_add_u32 m0, s49, 0
  s_nop 0
  buffer_load_dwordx4 v10, s[24:27], s36 offen lds
  s_add_u32 m0, s49, 1024
  s_nop 0
  buffer_load_dwordx4 v11, s[24:27], s36 offen lds
  s_add_u32 m0, s49, 2048
  s_nop 0
  buffer_load_dwordx4 v12, s[24:27], s36 offen lds
  s_add_u32 m0, s41, s43
  s_nop 0
  buffer_load_dwordx4 v13, s[32:35], s39 offen lds
  s_add_u32 m0, s49, 15360
  s_nop 0
  buffer_load_dwordx4 v10, s[24:27], s37 offen lds
  s_add_u32 m0, s49, 16384
  s_nop 0
  buffer_load_dwordx4 v11, s[24:27], s37 offen lds
  s_add_u32 m0, s49, 17408
  s_nop 0
  buffer_load_dwordx4 v12, s[24:27], s37 offen lds
  s_add_u32 m0, s41, s44
  s_nop 0
  buffer_load_dwordx4 v14, s[32:35], s40 offen lds
  s_add_u32 s42, s42, 1
  s_cmp_eq_u32 s42, 10
  s_cselect_b32 s42, 0, s42
  s_add_u32 s41, s41, 49152
  s_cmp_eq_u32 s41, 147456
  s_cselect_b32 s41, 0, s41
  s_mul_i32 s36, s42, 245760
  s_add_u32 s37, s36, 122880
  s_lshl_b32 s38, s42, 7
  s_cmp_eq_u32 s59, 3
  s_cselect_b32 s39, s38, s36
  s_cselect_b32 s40, s38, s37
  s_add_u32 s49, s41, s46
  s_add_u32 m0, s49, 0
  s_nop 0
  buffer_load_dwordx4 v16, s[28:31], s38 offen lds
  s_add_u32 m0, s49, 1024
  s_nop 0
  buffer_load_dwordx4 v17, s[28:31], s38 offen lds
  s_add_u32 m0, s49, 2048
  s_nop 0
  buffer_load_dwordx4 v18, s[28:31], s38 offen lds
  s_add_u32 m0, s49, 3072
  s_nop 0
  buffer_load_dwordx4 v19, s[28:31], s38 offen lds
  s_add_u32 s49, s41, s45
  s_add_u32 m0, s49, 0
  s_nop 0
  buffer_load_dwordx4 v10, s[24:27], s36 offen lds
  s_add_u32 m0, s49, 1024
  s_nop 0
  buffer_load_dwordx4 v11, s[24:27], s36 offen lds
  s_add_u32 m0, s49, 2048
  s_nop 0
  buffer_load_dwordx4 v12, s[24:27], s36 offen lds
  s_add_u32 m0, s41, s43
  s_nop 0
  buffer_load_dwordx4 v13, s[32:35], s39 offen lds
  s_add_u32 m0, s49, 15360
  s_nop 0
  buffer_load_dwordx4 v10, s[24:27], s37 offen lds
  s_add_u32 m0, s49, 16384
  s_nop 0
  buffer_load_dwordx4 v11, s[24:27], s37 offen lds
  s_add_u32 m0, s49, 17408
  s_nop 0
  buffer_load_dwordx4 v12, s[24:27], s37 offen lds
  s_add_u32 m0, s41, s44
  s_nop 0
  buffer_load_dwordx4 v14, s[32:35], s40 offen lds
  s_add_u32 s42, s42, 1
  s_cmp_eq_u32 s42, 10
  s_cselect_b32 s42, 0, s42
  s_add_u32 s41, s41, 49152
  s_cmp_eq_u32 s41, 147456
  s_cselect_b32 s41, 0, s41
  s_mov_b32 s48, 8
QL_LOOP:
  s_waitcnt vmcnt(12)
  s_barrier
  s_mul_i32 s36, s42, 245760
  s_add_u32 s37, s36, 122880
  s_lshl_b32 s38, s42, 7
  s_cmp_eq_u32 s59, 3
  s_cselect_b32 s39, s38, s36
  s_cselect_b32 s40, s38, s37
  s_add_u32 s49, s41, s46
  s_add_u32 m0, s49, 0
  s_nop 0
  buffer_load_dwordx4 v16, s[28:31], s38 offen lds
  s_add_u32 m0, s49, 1024
  s_nop 0
  buffer_load_dwordx4 v17, s[28:31], s38 offen lds
  s_add_u32 m0, s49, 2048
  s_nop 0
  buffer_load_dwordx4 v18, s[28:31], s38 offen lds
  s_add_u32 m0, s49, 3072
  s_nop 0
  buffer_load_dwordx4 v19, s[28:31], s38 offen lds
  s_add_u32 s49, s41, s45
  s_add_u32 m0, s49, 0
  s_nop 0
  buffer_load_dwordx4 v10, s[24:27], s36 offen lds
  s_add_u32 m0, s49, 1024
  s_nop 0
  buffer_load_dwordx4 v11, s[24:27], s36 offen lds
  s_add_u32 m0, s49, 2048
  s_nop 0
  buffer_load_dwordx4 v12, s[24:27], s36 offen lds
  s_add_u32 m0, s41, s43
  s_nop 0
  buffer_load_dwordx4 v13, s[32:35], s39 offen lds
  s_add_u32 m0, s49, 15360
  s_nop 0
  buffer_load_dwordx4 v10, s[24:27], s37 offen lds
  s_add_u32 m0, s49, 16384
  s_nop 0
  buffer_load_dwordx4 v11, s[24:27], s37 offen lds
  s_add_u32 m0, s49, 17408
  s_nop 0
  buffer_load_dwordx4 v12, s[24:27], s37 offen lds
  s_add_u32 m0, s41, s44
  s_nop 0
  buffer_load_dwordx4 v14, s[32:35], s40 offen lds
  s_add_u32 s42, s42, 1
  s_cmp_eq_u32 s42, 10
  s_cselect_b32 s42, 0, s42
  s_add_u32 s41, s41, 49152
  s_cmp_eq_u32 s41, 147456
  s_cselect_b32 s41, 0, s41
  s_sub_u32 s48, s48, 1
  s_cmp_lg_u32 s48, 0
  s_cbranch_scc1 QL_LOOP
  s_waitcnt vmcnt(12)
  s_barrier
  s_waitcnt vmcnt(0)
  s_barrier
  s_endpgm
K1_MLP:
  s_cmp_ge_u32 s3, 4
  s_cbranch_scc1 K1_ML
  s_and_b32 s57, s59, 1
  v_min_u32 v8, 23, v1
  v_mul_u32_u24 v9, 43, v8
  v_lshrrev_b32 v9, 8, v9
  v_mul_u32_u24 v10, 6, v9
  v_sub_u32 v8, v8, v10
  v_mul_u32_u24 v9, 3840, v9
  v_lshrrev_b32 v10, 1, v8
  v_mul_u32_u24 v10, 1280, v10
  v_add_u32 v9, v9, v10
  v_and_b32 v8, 1, v8
  v_mul_u32_u24 v8, 156, v8
  v_add_u32 v9, v9, v8
  s_lshr_b32 s60, s52, 2
  s_mul_i32 s60, s60, 5
  s_and_b32 s61, s53, 1
  s_lshl_b32 s61, s61, 1
  s_add_u32 s60, s60, s61
  s_add_u32 s60, s60, 4
  s_sub_u32 s61, s60, 10
  s_cmp_ge_u32 s60, 10
  s_cselect_b32 s60, s61, s60
  s_lshl_b32 s60, s60, 2
  s_and_b32 s61, s52, 3
  s_add_u32 s60, s60, s61
  s_lshl_b32 s60, s60, 2
  s_add_u32 s60, s60, s59
  s_mul_i32 s60, s60, 15360
  s_mul_i32 s61, s55, 160
  s_add_u32 s60, s60, s61
  s_waitcnt lgkmcnt(0)
  s_mov_b32 s84, s6
  s_and_b32 s85, s7, 0xffff
  s_mov_b32 s86, 2457600
  s_mov_b32 s87, 0x00020000
  buffer_load_dword v200, v9, s[84:87], s60 offen
  s_getpc_b64 s[92:93]
CWL_6:
  s_sub_u32 s92, s92, CWL_6-gm1_kernel
  s_subb_u32 s93, s93, 0
  s_lshl_b32 s94, s51, 2
  s_add_u32 s94, s94, s59
  s_mul_i32 s94, s94, 384
  s_min_u32 s94, s94, CODE_END-gm1_kernel-384
  s_add_u32 s92, s92, s94
  s_addc_u32 s93, s93, 0
  s_load_dword s95, s[92:93], 0
  s_load_dword s95, s[92:93], 64
  s_load_dword s95, s[92:93], 128
  s_load_dword s95, s[92:93], 192
  s_load_dword s95, s[92:93], 256
  s_load_dword s95, s[92:93], 320
  s_mov_b32 s28, s14
  s_and_b32 s29, s15, 0xffff
  s_mov_b32 s30, 3072
  s_mov_b32 s31, 0x00020000
  v_lshrrev_b32 v9, 4, v1
  v_lshlrev_b32 v9, 3, v9
  s_mul_i32 s60, s55, 384
  s_mul_i32 s61, s57, 192
  s_add_u32 s60, s60, s61
  buffer_load_dwordx2 v[40:41], v9, s[28:31], s60 offen offset:0
  buffer_load_dwordx2 v[44:45], v9, s[28:31], s60 offen offset:32
  buffer_load_dwordx2 v[48:49], v9, s[28:31], s60 offen offset:64
  buffer_load_dwordx2 v[52:53], v9, s[28:31], s60 offen offset:96
  buffer_load_dwordx2 v[56:57], v9, s[28:31], s60 offen offset:128
  buffer_load_dwordx2 v[60:61], v9, s[28:31], s60 offen offset:160
  v_lshrrev_b32 v8, 5, v1
  v_lshlrev_b32 v8, 4, v8
  v_bfe_u32 v9, v1, 2, 3
  v_add_u32 v8, v8, v9
  v_bfe_u32 v9, v8, 1, 2
  v_mul_u32_u24 v8, 384, v8
  v_and_b32 v10, 3, v1
  v_lshl_add_u32 v8, v10, 3, v8
  s_lshl_b32 s60, s57, 1
  v_xor_b32 v9, s60, v9
  s_lshl_b32 s60, s57, 7
  v_add_u32 v8, s60, v8
  v_xor_b32 v10, 0, v9
  v_lshl_add_u32 v2, v10, 5, v8
  v_xor_b32 v10, 1, v9
  v_lshl_add_u32 v3, v10, 5, v8
  v_add_u32 v8, s60, v8
  v_xor_b32 v10, 2, v9
  v_lshl_add_u32 v4, v10, 5, v8
  v_xor_b32 v10, 3, v9
  v_lshl_add_u32 v5, v10, 5, v8
  v_and_b32 v9, 15, v1
  v_lshrrev_b32 v10, 1, v9
  v_lshrrev_b32 v6, 4, v1
  v_xor_b32 v6, v6, v10
  v_lshlrev_b32 v6, 4, v6
  v_lshl_add_u32 v6, v9, 7, v6
  v_add_u32 v6, 24576, v6
  v_xor_b32 v7, 64, v6
  s_lshr_b32 s60, s59, 1
  s_lshl_b32 s60, s60, 13
  v_add_u32 v6, s60, v6
  v_add_u32 v7, s60, v7
  s_mov_b32 s24, s22
  s_and_b32 s25, s23, 0xffff
  s_mov_b32 s26, 8912896
  s_mov_b32 s27, 0x00020000
  s_lshl_b32 s36, s54, 1
  s_lshr_b32 s37, s59, 1
  s_add_u32 s36, s36, s37
  s_mul_i32 s36, s36, 68
  s_mul_i32 s37, s55, 6
  s_add_u32 s37, s37, 20
  s_add_u32 s36, s36, s37
  s_mul_i32 s37, s57, 3
  s_add_u32 s36, s36, s37
  s_lshl_b32 s36, s36, 12
  s_add_u32 s37, s36, 4096
  s_add_u32 s38, s36, 8192
  v_mov_b32 v8, v2
  v_mov_b32 v9, v3
  v_mov_b32 v10, v4
  v_mov_b32 v11, v5
  v_mov_b32 v12, v6
  v_mov_b32 v13, v7
  v_lshlrev_b32 v14, 4, v1
  s_waitcnt vmcnt(0)
  v_lshlrev_b32 v16, 16, v40
  v_and_b32 v17, 0xffff0000, v40
  v_lshlrev_b32 v18, 16, v41
  v_and_b32 v19, 0xffff0000, v41
  v_mov_b32 v40, v16
  v_mov_b32 v41, v17
  v_mov_b32 v42, v18
  v_mov_b32 v43, v19
  v_mov_b32 v64, v16
  v_mov_b32 v65, v17
  v_mov_b32 v66, v18
  v_mov_b32 v67, v19
  v_mov_b32 v88, v16
  v_mov_b32 v89, v17
  v_mov_b32 v90, v18
  v_mov_b32 v91, v19
  v_lshlrev_b32 v20, 16, v44
  v_and_b32 v21, 0xffff0000, v44
  v_lshlrev_b32 v22, 16, v45
  v_and_b32 v23, 0xffff0000, v45
  v_mov_b32 v44, v20
  v_mov_b32 v45, v21
  v_mov_b32 v46, v22
  v_mov_b32 v47, v23
  v_mov_b32 v68, v20
  v_mov_b32 v69, v21
  v_mov_b32 v70, v22
  v_mov_b32 v71, v23
  v_mov_b32 v92, v20
  v_mov_b32 v93, v21
  v_mov_b32 v94, v22
  v_mov_b32 v95, v23
  v_lshlrev_b32 v24, 16, v48
  v_and_b32 v25, 0xffff0000, v48
  v_lshlrev_b32 v26, 16, v49
  v_and_b32 v27, 0xffff0000, v49
  v_mov_b32 v48, v24
  v_mov_b32 v49, v25
  v_mov_b32 v50, v26
  v_mov_b32 v51, v27
  v_mov_b32 v72, v24
  v_mov_b32 v73, v25
  v_mov_b32 v74, v26
  v_mov_b32 v75, v27
  v_mov_b32 v96, v24
  v_mov_b32 v97, v25
  v_mov_b32 v98, v26
  v_mov_b32 v99, v27
  v_lshlrev_b32 v28, 16, v52
  v_and_b32 v29, 0xffff0000, v52
  v_lshlrev_b32 v30, 16, v53
  v_and_b32 v31, 0xffff0000, v53
  v_mov_b32 v52, v28
  v_mov_b32 v53, v29
  v_mov_b32 v54, v30
  v_mov_b32 v55, v31
  v_mov_b32 v76, v28
  v_mov_b32 v77, v29
  v_mov_b32 v78, v30
  v_mov_b32 v79, v31
  v_mov_b32 v100, v28
  v_mov_b32 v101, v29
  v_mov_b32 v102, v30
  v_mov_b32 v103, v31
  v_lshlrev_b32 v32, 16, v56
  v_and_b32 v33, 0xffff0000, v56
  v_lshlrev_b32 v34, 16, v57
  v_and_b32 v35, 0xffff0000, v57
  v_mov_b32 v56, v32
  v_mov_b32 v57, v33
  v_mov_b32 v58, v34
  v_mov_b32 v59, v35
  v_mov_b32 v80, v32
  v_mov_b32 v81, v33
  v_mov_b32 v82, v34
  v_mov_b32 v83, v35
  v_mov_b32 v104, v32
  v_mov_b32 v105, v33
  v_mov_b32 v106, v34
  v_mov_b32 v107, v35
  v_lshlrev_b32 v36, 16, v60
  v_and_b32 v37, 0xffff0000, v60
  v_lshlrev_b32 v38, 16, v61
  v_and_b32 v39, 0xffff0000, v61
  v_mov_b32 v60, v36
  v_mov_b32 v61, v37
  v_mov_b32 v62, v38
  v_mov_b32 v63, v39
  v_mov_b32 v84, v36
  v_mov_b32 v85, v37
  v_mov_b32 v86, v38
  v_mov_b32 v87, v39
  v_mov_b32 v108, v36
  v_mov_b32 v109, v37
  v_mov_b32 v110, v38
  v_mov_b32 v111, v39
  s_mov_b32 s47, 0
  s_mov_b32 s48, 10
  s_barrier
  ds_read_b128 a[16:19], v12 offset:0
  ds_read_b64_tr_b16 a[0:1], v8 offset:0
  ds_read_b64_tr_b16 a[2:3], v8 offset:3072
  ds_read_b128 a[20:23], v12 offset:2048
  ds_read_b128 a[24:27], v12 offset:4096
  ds_read_b128 a[28:31], v12 offset:6144
  ds_read_b64_tr_b16 a[4:5], v9 offset:0
  ds_read_b64_tr_b16 a[6:7], v9 offset:3072
  ds_read_b64_tr_b16 a[8:9], v10 offset:0
  ds_read_b64_tr_b16 a[10:11], v10 offset:3072
  ds_read_b64_tr_b16 a[12:13], v11 offset:0
  ds_read_b64_tr_b16 a[14:15], v11 offset:3072
MC_LOOP:
  s_waitcnt lgkmcnt(9)
  v_mfma_f32_16x16x32_bf16 v[16:19], a[0:3], a[16:19], v[16:19]
  s_waitcnt lgkmcnt(8)
  v_mfma_f32_16x16x32_bf16 v[40:43], a[0:3], a[20:23], v[40:43]
  s_waitcnt lgkmcnt(7)
  v_mfma_f32_16x16x32_bf16 v[64:67], a[0:3], a[24:27], v[64:67]
  s_waitcnt lgkmcnt(6)
  v_mfma_f32_16x16x32_bf16 v[88:91], a[0:3], a[28:31], v[88:91]
  ds_read_b64_tr_b16 a[0:1], v8 offset:128
  ds_read_b64_tr_b16 a[2:3], v8 offset:3200
  s_waitcnt lgkmcnt(6)
  v_mfma_f32_16x16x32_bf16 v[20:23], a[4:7], a[16:19], v[20:23]
  ds_read_b128 a[32:35], v13 offset:0
  v_mfma_f32_16x16x32_bf16 v[44:47], a[4:7], a[20:23], v[44:47]
  v_mfma_f32_16x16x32_bf16 v[68:71], a[4:7], a[24:27], v[68:71]
  v_mfma_f32_16x16x32_bf16 v[92:95], a[4:7], a[28:31], v[92:95]
  ds_read_b64_tr_b16 a[4:5], v9 offset:128
  ds_read_b64_tr_b16 a[6:7], v9 offset:3200
  s_waitcnt lgkmcnt(7)
  v_mfma_f32_16x16x32_bf16 v[24:27], a[8:11], a[16:19], v[24:27]
  ds_read_b128 a[36:39], v13 offset:2048
  v_mfma_f32_16x16x32_bf16 v[48:51], a[8:11], a[20:23], v[48:51]
  v_mfma_f32_16x16x32_bf16 v[72:75], a[8:11], a[24:27], v[72:75]
  v_mfma_f32_16x16x32_bf16 v[96:99], a[8:11], a[28:31], v[96:99]
  ds_read_b64_tr_b16 a[8:9], v8 offset:12288
  ds_read_b64_tr_b16 a[10:11], v8 offset:15360
  s_waitcnt lgkmcnt(8)
  v_mfma_f32_16x16x32_bf16 v[28:31], a[12:15], a[16:19], v[28:31]
  ds_read_b128 a[40:43], v13 offset:4096
  v_mfma_f32_16x16x32_bf16 v[52:55], a[12:15], a[20:23], v[52:55]
  v_mfma_f32_16x16x32_bf16 v[76:79], a[12:15], a[24:27], v[76:79]
  v_mfma_f32_16x16x32_bf16 v[100:103], a[12:15], a[28:31], v[100:103]
  ds_read_b64_tr_b16 a[12:13], v9 offset:12288
  ds_read_b64_tr_b16 a[14:15], v9 offset:15360
  s_waitcnt lgkmcnt(9)
  v_mfma_f32_16x16x32_bf16 v[32:35], a[0:3], a[16:19], v[32:35]
  ds_read_b128 a[44:47], v13 offset:6144
  v_mfma_f32_16x16x32_bf16 v[56:59], a[0:3], a[20:23], v[56:59]
  v_mfma_f32_16x16x32_bf16 v[80:83], a[0:3], a[24:27], v[80:83]
  v_mfma_f32_16x16x32_bf16 v[104:107], a[0:3], a[28:31], v[104:107]
  ds_read_b64_tr_b16 a[0:1], v10 offset:12288
  s_waitcnt lgkmcnt(8)
  v_mfma_f32_16x16x32_bf16 v[36:39], a[4:7], a[16:19], v[36:39]
  ds_read_b64_tr_b16 a[2:3], v10 offset:15360
  v_mfma_f32_16x16x32_bf16 v[60:63], a[4:7], a[20:23], v[60:63]
  v_mfma_f32_16x16x32_bf16 v[84:87], a[4:7], a[24:27], v[84:87]
  v_mfma_f32_16x16x32_bf16 v[108:111], a[4:7], a[28:31], v[108:111]
  ds_read_b64_tr_b16 a[4:5], v11 offset:12288
  s_waitcnt lgkmcnt(7)
  v_mfma_f32_16x16x32_bf16 v[16:19], a[8:11], a[32:35], v[16:19]
  ds_read_b64_tr_b16 a[6:7], v11 offset:15360
  v_mfma_f32_16x16x32_bf16 v[40:43], a[8:11], a[36:39], v[40:43]
  s_waitcnt lgkmcnt(7)
  v_mfma_f32_16x16x32_bf16 v[64:67], a[8:11], a[40:43], v[64:67]
  s_waitcnt lgkmcnt(4)
  v_mfma_f32_16x16x32_bf16 v[88:91], a[8:11], a[44:47], v[88:91]
  ds_read_b64_tr_b16 a[8:9], v8 offset:12416
  v_mfma_f32_16x16x32_bf16 v[20:23], a[12:15], a[32:35], v[20:23]
  ds_read_b64_tr_b16 a[10:11], v8 offset:15488
  v_mfma_f32_16x16x32_bf16 v[44:47], a[12:15], a[36:39], v[44:47]
  v_mfma_f32_16x16x32_bf16 v[68:71], a[12:15], a[40:43], v[68:71]
  v_mfma_f32_16x16x32_bf16 v[92:95], a[12:15], a[44:47], v[92:95]
  ds_read_b64_tr_b16 a[12:13], v9 offset:12416
  ds_read_b64_tr_b16 a[14:15], v9 offset:15488
  s_waitcnt lgkmcnt(6)
  v_mfma_f32_16x16x32_bf16 v[24:27], a[0:3], a[32:35], v[24:27]
  s_add_u32 s47, s47, 40960
  s_cmp_eq_u32 s47, 122880
  v_mfma_f32_16x16x32_bf16 v[48:51], a[0:3], a[36:39], v[48:51]
  s_cselect_b32 s47, 0, s47
  v_add_u32 v8, s47, v2
  v_mfma_f32_16x16x32_bf16 v[72:75], a[0:3], a[40:43], v[72:75]
  v_add_u32 v9, s47, v3
  v_add_u32 v10, s47, v4
  v_mfma_f32_16x16x32_bf16 v[96:99], a[0:3], a[44:47], v[96:99]
  v_add_u32 v11, s47, v5
  v_add_u32 v12, s47, v6
  s_waitcnt lgkmcnt(4)
  v_mfma_f32_16x16x32_bf16 v[28:31], a[4:7], a[32:35], v[28:31]
  v_add_u32 v13, s47, v7
  s_sub_u32 s48, s48, 1
  v_mfma_f32_16x16x32_bf16 v[52:55], a[4:7], a[36:39], v[52:55]
  v_mfma_f32_16x16x32_bf16 v[76:79], a[4:7], a[40:43], v[76:79]
  v_mfma_f32_16x16x32_bf16 v[100:103], a[4:7], a[44:47], v[100:103]
  s_waitcnt lgkmcnt(0)
  s_barrier
  v_mfma_f32_16x16x32_bf16 v[32:35], a[8:11], a[32:35], v[32:35]
  ds_read_b128 a[16:19], v12 offset:0
  ds_read_b64_tr_b16 a[0:1], v8 offset:0
  v_mfma_f32_16x16x32_bf16 v[56:59], a[8:11], a[36:39], v[56:59]
  ds_read_b64_tr_b16 a[2:3], v8 offset:3072
  ds_read_b128 a[20:23], v12 offset:2048
  v_mfma_f32_16x16x32_bf16 v[80:83], a[8:11], a[40:43], v[80:83]
  ds_read_b128 a[24:27], v12 offset:4096
  ds_read_b128 a[28:31], v12 offset:6144
  v_mfma_f32_16x16x32_bf16 v[104:107], a[8:11], a[44:47], v[104:107]
  ds_read_b64_tr_b16 a[4:5], v9 offset:0
  ds_read_b64_tr_b16 a[6:7], v9 offset:3072
  v_mfma_f32_16x16x32_bf16 v[36:39], a[12:15], a[32:35], v[36:39]
  ds_read_b64_tr_b16 a[8:9], v10 offset:0
  ds_read_b64_tr_b16 a[10:11], v10 offset:3072
  v_mfma_f32_16x16x32_bf16 v[60:63], a[12:15], a[36:39], v[60:63]
  v_mfma_f32_16x16x32_bf16 v[84:87], a[12:15], a[40:43], v[84:87]
  v_mfma_f32_16x16x32_bf16 v[108:111], a[12:15], a[44:47], v[108:111]
  s_cmp_lg_u32 s48, 0
  ds_read_b64_tr_b16 a[12:13], v11 offset:0
  ds_read_b64_tr_b16 a[14:15], v11 offset:3072
  s_cbranch_scc1 MC_LOOP
  s_mov_b32 s60, 0xc0135761
  s_mov_b32 s61, 0xbdd2d3e8
  v_mov_b32 v15, s60
  s_nop 4
  v_mul_f32 v112, v16, v16
  v_mul_f32 v113, v17, v17
  v_mul_f32 v114, v18, v18
  v_mul_f32 v115, v19, v19
  v_mul_f32 v116, v20, v20
  v_mul_f32 v117, v21, v21
  v_mul_f32 v118, v22, v22
  v_mul_f32 v119, v23, v23
  v_fma_f32 v112, v112, s61, v15
  v_fma_f32 v113, v113, s61, v15
  v_fma_f32 v114, v114, s61, v15
  v_fma_f32 v115, v115, s61, v15
  v_fma_f32 v116, v116, s61, v15
  v_fma_f32 v117, v117, s61, v15
  v_fma_f32 v118, v118, s61, v15
  v_fma_f32 v119, v119, s61, v15
  v_mul_f32 v112, v112, v16
  v_mul_f32 v113, v113, v17
  v_mul_f32 v114, v114, v18
  v_mul_f32 v115, v115, v19
  v_mul_f32 v116, v116, v20
  v_mul_f32 v117, v117, v21
  v_mul_f32 v118, v118, v22
  v_mul_f32 v119, v119, v23
  v_exp_f32 v112, v112
  v_exp_f32 v113, v113
  v_exp_f32 v114, v114
  v_exp_f32 v115, v115
  v_exp_f32 v116, v116
  v_exp_f32 v117, v117
  v_exp_f32 v118, v118
  v_exp_f32 v119, v119
  v_add_f32 v112, 1.0, v112
  v_add_f32 v113, 1.0, v113
  v_add_f32 v114, 1.0, v114
  v_add_f32 v115, 1.0, v115
  v_add_f32 v116, 1.0, v116
  v_add_f32 v117, 1.0, v117
  v_add_f32 v118, 1.0, v118
  v_add_f32 v119, 1.0, v119
  v_rcp_f32 v112, v112
  v_rcp_f32 v113, v113
  v_rcp_f32 v114, v114
  v_rcp_f32 v115, v115
  v_rcp_f32 v116, v116
  v_rcp_f32 v117, v117
  v_rcp_f32 v118, v118
  v_rcp_f32 v119, v119
  v_mul_f32 v16, v16, v112
  v_mul_f32 v17, v17, v113
  v_mul_f32 v18, v18, v114
  v_mul_f32 v19, v19, v115
  v_mul_f32 v20, v20, v116
  v_mul_f32 v21, v21, v117
  v_mul_f32 v22, v22, v118
  v_mul_f32 v23, v23, v119
  v_cvt_pk_bf16_f32 v16, v16, v17
  v_cvt_pk_bf16_f32 v17, v18, v19
  v_cvt_pk_bf16_f32 v18, v20, v21
  v_cvt_pk_bf16_f32 v19, v22, v23
  buffer_store_dwordx4 v[16:19], v14, s[24:27], s36 offen offset:0 sc1
  v_mul_f32 v120, v24, v24
  v_mul_f32 v121, v25, v25
  v_mul_f32 v122, v26, v26
  v_mul_f32 v123, v27, v27
  v_mul_f32 v124, v28, v28
  v_mul_f32 v125, v29, v29
  v_mul_f32 v126, v30, v30
  v_mul_f32 v127, v31, v31
  v_fma_f32 v120, v120, s61, v15
  v_fma_f32 v121, v121, s61, v15
  v_fma_f32 v122, v122, s61, v15
  v_fma_f32 v123, v123, s61, v15
  v_fma_f32 v124, v124, s61, v15
  v_fma_f32 v125, v125, s61, v15
  v_fma_f32 v126, v126, s61, v15
  v_fma_f32 v127, v127, s61, v15
  v_mul_f32 v120, v120, v24
  v_mul_f32 v121, v121, v25
  v_mul_f32 v122, v122, v26
  v_mul_f32 v123, v123, v27
  v_mul_f32 v124, v124, v28
  v_mul_f32 v125, v125, v29
  v_mul_f32 v126, v126, v30
  v_mul_f32 v127, v127, v31
  v_exp_f32 v120, v120
  v_exp_f32 v121, v121
  v_exp_f32 v122, v122
  v_exp_f32 v123, v123
  v_exp_f32 v124, v124
  v_exp_f32 v125, v125
  v_exp_f32 v126, v126
  v_exp_f32 v127, v127
  v_add_f32 v120, 1.0, v120
  v_add_f32 v121, 1.0, v121
  v_add_f32 v122, 1.0, v122
  v_add_f32 v123, 1.0, v123
  v_add_f32 v124, 1.0, v124
  v_add_f32 v125, 1.0, v125
  v_add_f32 v126, 1.0, v126
  v_add_f32 v127, 1.0, v127
  v_rcp_f32 v120, v120
  v_rcp_f32 v121, v121
  v_rcp_f32 v122, v122
  v_rcp_f32 v123, v123
  v_rcp_f32 v124, v124
  v_rcp_f32 v125, v125
  v_rcp_f32 v126, v126
  v_rcp_f32 v127, v127
  v_mul_f32 v24, v24, v120
  v_mul_f32 v25, v25, v121
  v_mul_f32 v26, v26, v122
  v_mul_f32 v27, v27, v123
  v_mul_f32 v28, v28, v124
  v_mul_f32 v29, v29, v125
  v_mul_f32 v30, v30, v126
  v_mul_f32 v31, v31, v127
  v_cvt_pk_bf16_f32 v24, v24, v25
  v_cvt_pk_bf16_f32 v25, v26, v27
  v_cvt_pk_bf16_f32 v26, v28, v29
  v_cvt_pk_bf16_f32 v27, v30, v31
  buffer_store_dwordx4 v[24:27], v14, s[24:27], s37 offen offset:0 sc1
  v_mul_f32 v112, v32, v32
  v_mul_f32 v113, v33, v33
  v_mul_f32 v114, v34, v34
  v_mul_f32 v115, v35, v35
  v_mul_f32 v116, v36, v36
  v_mul_f32 v117, v37, v37
  v_mul_f32 v118, v38, v38
  v_mul_f32 v119, v39, v39
  v_fma_f32 v112, v112, s61, v15
  v_fma_f32 v113, v113, s61, v15
  v_fma_f32 v114, v114, s61, v15
  v_fma_f32 v115, v115, s61, v15
  v_fma_f32 v116, v116, s61, v15
  v_fma_f32 v117, v117, s61, v15
  v_fma_f32 v118, v118, s61, v15
  v_fma_f32 v119, v119, s61, v15
  v_mul_f32 v112, v112, v32
  v_mul_f32 v113, v113, v33
  v_mul_f32 v114, v114, v34
  v_mul_f32 v115, v115, v35
  v_mul_f32 v116, v116, v36
  v_mul_f32 v117, v117, v37
  v_mul_f32 v118, v118, v38
  v_mul_f32 v119, v119, v39
  v_exp_f32 v112, v112
  v_exp_f32 v113, v113
  v_exp_f32 v114, v114
  v_exp_f32 v115, v115
  v_exp_f32 v116, v116
  v_exp_f32 v117, v117
  v_exp_f32 v118, v118
  v_exp_f32 v119, v119
  v_add_f32 v112, 1.0, v112
  v_add_f32 v113, 1.0, v113
  v_add_f32 v114, 1.0, v114
  v_add_f32 v115, 1.0, v115
  v_add_f32 v116, 1.0, v116
  v_add_f32 v117, 1.0, v117
  v_add_f32 v118, 1.0, v118
  v_add_f32 v119, 1.0, v119
  v_rcp_f32 v112, v112
  v_rcp_f32 v113, v113
  v_rcp_f32 v114, v114
  v_rcp_f32 v115, v115
  v_rcp_f32 v116, v116
  v_rcp_f32 v117, v117
  v_rcp_f32 v118, v118
  v_rcp_f32 v119, v119
  v_mul_f32 v32, v32, v112
  v_mul_f32 v33, v33, v113
  v_mul_f32 v34, v34, v114
  v_mul_f32 v35, v35, v115
  v_mul_f32 v36, v36, v116
  v_mul_f32 v37, v37, v117
  v_mul_f32 v38, v38, v118
  v_mul_f32 v39, v39, v119
  v_cvt_pk_bf16_f32 v32, v32, v33
  v_cvt_pk_bf16_f32 v33, v34, v35
  v_cvt_pk_bf16_f32 v34, v36, v37
  v_cvt_pk_bf16_f32 v35, v38, v39
  buffer_store_dwordx4 v[32:35], v14, s[24:27], s38 offen offset:0 sc1
  v_mul_f32 v120, v40, v40
  v_mul_f32 v121, v41, v41
  v_mul_f32 v122, v42, v42
  v_mul_f32 v123, v43, v43
  v_mul_f32 v124, v44, v44
  v_mul_f32 v125, v45, v45
  v_mul_f32 v126, v46, v46
  v_mul_f32 v127, v47, v47
  v_fma_f32 v120, v120, s61, v15
  v_fma_f32 v121, v121, s61, v15
  v_fma_f32 v122, v122, s61, v15
  v_fma_f32 v123, v123, s61, v15
  v_fma_f32 v124, v124, s61, v15
  v_fma_f32 v125, v125, s61, v15
  v_fma_f32 v126, v126, s61, v15
  v_fma_f32 v127, v127, s61, v15
  v_mul_f32 v120, v120, v40
  v_mul_f32 v121, v121, v41
  v_mul_f32 v122, v122, v42
  v_mul_f32 v123, v123, v43
  v_mul_f32 v124, v124, v44
  v_mul_f32 v125, v125, v45
  v_mul_f32 v126, v126, v46
  v_mul_f32 v127, v127, v47
  v_exp_f32 v120, v120
  v_exp_f32 v121, v121
  v_exp_f32 v122, v122
  v_exp_f32 v123, v123
  v_exp_f32 v124, v124
  v_exp_f32 v125, v125
  v_exp_f32 v126, v126
  v_exp_f32 v127, v127
  v_add_f32 v120, 1.0, v120
  v_add_f32 v121, 1.0, v121
  v_add_f32 v122, 1.0, v122
  v_add_f32 v123, 1.0, v123
  v_add_f32 v124, 1.0, v124
  v_add_f32 v125, 1.0, v125
  v_add_f32 v126, 1.0, v126
  v_add_f32 v127, 1.0, v127
  v_rcp_f32 v120, v120
  v_rcp_f32 v121, v121
  v_rcp_f32 v122, v122
  v_rcp_f32 v123, v123
  v_rcp_f32 v124, v124
  v_rcp_f32 v125, v125
  v_rcp_f32 v126, v126
  v_rcp_f32 v127, v127
  v_mul_f32 v40, v40, v120
  v_mul_f32 v41, v41, v121
  v_mul_f32 v42, v42, v122
  v_mul_f32 v43, v43, v123
  v_mul_f32 v44, v44, v124
  v_mul_f32 v45, v45, v125
  v_mul_f32 v46, v46, v126
  v_mul_f32 v47, v47, v127
  v_cvt_pk_bf16_f32 v40, v40, v41
  v_cvt_pk_bf16_f32 v41, v42, v43
  v_cvt_pk_bf16_f32 v42, v44, v45
  v_cvt_pk_bf16_f32 v43, v46, v47
  buffer_store_dwordx4 v[40:43], v14, s[24:27], s36 offen offset:1024 sc1
  v_mul_f32 v112, v48, v48
  v_mul_f32 v113, v49, v49
  v_mul_f32 v114, v50, v50
  v_mul_f32 v115, v51, v51
  v_mul_f32 v116, v52, v52
  v_mul_f32 v117, v53, v53
  v_mul_f32 v118, v54, v54
  v_mul_f32 v119, v55, v55
  v_fma_f32 v112, v112, s61, v15
  v_fma_f32 v113, v113, s61, v15
  v_fma_f32 v114, v114, s61, v15
  v_fma_f32 v115, v115, s61, v15
  v_fma_f32 v116, v116, s61, v15
  v_fma_f32 v117, v117, s61, v15
  v_fma_f32 v118, v118, s61, v15
  v_fma_f32 v119, v119, s61, v15
  v_mul_f32 v112, v112, v48
  v_mul_f32 v113, v113, v49
  v_mul_f32 v114, v114, v50
  v_mul_f32 v115, v115, v51
  v_mul_f32 v116, v116, v52
  v_mul_f32 v117, v117, v53
  v_mul_f32 v118, v118, v54
  v_mul_f32 v119, v119, v55
  v_exp_f32 v112, v112
  v_exp_f32 v113, v113
  v_exp_f32 v114, v114
  v_exp_f32 v115, v115
  v_exp_f32 v116, v116
  v_exp_f32 v117, v117
  v_exp_f32 v118, v118
  v_exp_f32 v119, v119
  v_add_f32 v112, 1.0, v112
  v_add_f32 v113, 1.0, v113
  v_add_f32 v114, 1.0, v114
  v_add_f32 v115, 1.0, v115
  v_add_f32 v116, 1.0, v116
  v_add_f32 v117, 1.0, v117
  v_add_f32 v118, 1.0, v118
  v_add_f32 v119, 1.0, v119
  v_rcp_f32 v112, v112
  v_rcp_f32 v113, v113
  v_rcp_f32 v114, v114
  v_rcp_f32 v115, v115
  v_rcp_f32 v116, v116
  v_rcp_f32 v117, v117
  v_rcp_f32 v118, v118
  v_rcp_f32 v119, v119
  v_mul_f32 v48, v48, v112
  v_mul_f32 v49, v49, v113
  v_mul_f32 v50, v50, v114
  v_mul_f32 v51, v51, v115
  v_mul_f32 v52, v52, v116
  v_mul_f32 v53, v53, v117
  v_mul_f32 v54, v54, v118
  v_mul_f32 v55, v55, v119
  v_cvt_pk_bf16_f32 v48, v48, v49
  v_cvt_pk_bf16_f32 v49, v50, v51
  v_cvt_pk_bf16_f32 v50, v52, v53
  v_cvt_pk_bf16_f32 v51, v54, v55
  buffer_store_dwordx4 v[48:51], v14, s[24:27], s37 offen offset:1024 sc1
  v_mul_f32 v120, v56, v56
  v_mul_f32 v121, v57, v57
  v_mul_f32 v122, v58, v58
  v_mul_f32 v123, v59, v59
  v_mul_f32 v124, v60, v60
  v_mul_f32 v125, v61, v61
  v_mul_f32 v126, v62, v62
  v_mul_f32 v127, v63, v63
  v_fma_f32 v120, v120, s61, v15
  v_fma_f32 v121, v121, s61, v15
  v_fma_f32 v122, v122, s61, v15
  v_fma_f32 v123, v123, s61, v15
  v_fma_f32 v124, v124, s61, v15
  v_fma_f32 v125, v125, s61, v15
  v_fma_f32 v126, v126, s61, v15
  v_fma_f32 v127, v127, s61, v15
  v_mul_f32 v120, v120, v56
  v_mul_f32 v121, v121, v57
  v_mul_f32 v122, v122, v58
  v_mul_f32 v123, v123, v59
  v_mul_f32 v124, v124, v60
  v_mul_f32 v125, v125, v61
  v_mul_f32 v126, v126, v62
  v_mul_f32 v127, v127, v63
  v_exp_f32 v120, v120
  v_exp_f32 v121, v121
  v_exp_f32 v122, v122
  v_exp_f32 v123, v123
  v_exp_f32 v124, v124
  v_exp_f32 v125, v125
  v_exp_f32 v126, v126
  v_exp_f32 v127, v127
  v_add_f32 v120, 1.0, v120
  v_add_f32 v121, 1.0, v121
  v_add_f32 v122, 1.0, v122
  v_add_f32 v123, 1.0, v123
  v_add_f32 v124, 1.0, v124
  v_add_f32 v125, 1.0, v125
  v_add_f32 v126, 1.0, v126
  v_add_f32 v127, 1.0, v127
  v_rcp_f32 v120, v120
  v_rcp_f32 v121, v121
  v_rcp_f32 v122, v122
  v_rcp_f32 v123, v123
  v_rcp_f32 v124, v124
  v_rcp_f32 v125, v125
  v_rcp_f32 v126, v126
  v_rcp_f32 v127, v127
  v_mul_f32 v56, v56, v120
  v_mul_f32 v57, v57, v121
  v_mul_f32 v58, v58, v122
  v_mul_f32 v59, v59, v123
  v_mul_f32 v60, v60, v124
  v_mul_f32 v61, v61, v125
  v_mul_f32 v62, v62, v126
  v_mul_f32 v63, v63, v127
  v_cvt_pk_bf16_f32 v56, v56, v57
  v_cvt_pk_bf16_f32 v57, v58, v59
  v_cvt_pk_bf16_f32 v58, v60, v61
  v_cvt_pk_bf16_f32 v59, v62, v63
  buffer_store_dwordx4 v[56:59], v14, s[24:27], s38 offen offset:1024 sc1
  v_mul_f32 v112, v64, v64
  v_mul_f32 v113, v65, v65
  v_mul_f32 v114, v66, v66
  v_mul_f32 v115, v67, v67
  v_mul_f32 v116, v68, v68
  v_mul_f32 v117, v69, v69
  v_mul_f32 v118, v70, v70
  v_mul_f32 v119, v71, v71
  v_fma_f32 v112, v112, s61, v15
  v_fma_f32 v113, v113, s61, v15
  v_fma_f32 v114, v114, s61, v15
  v_fma_f32 v115, v115, s61, v15
  v_fma_f32 v116, v116, s61, v15
  v_fma_f32 v117, v117, s61, v15
  v_fma_f32 v118, v118, s61, v15
  v_fma_f32 v119, v119, s61, v15
  v_mul_f32 v112, v112, v64
  v_mul_f32 v113, v113, v65
  v_mul_f32 v114, v114, v66
  v_mul_f32 v115, v115, v67
  v_mul_f32 v116, v116, v68
  v_mul_f32 v117, v117, v69
  v_mul_f32 v118, v118, v70
  v_mul_f32 v119, v119, v71
  v_exp_f32 v112, v112
  v_exp_f32 v113, v113
  v_exp_f32 v114, v114
  v_exp_f32 v115, v115
  v_exp_f32 v116, v116
  v_exp_f32 v117, v117
  v_exp_f32 v118, v118
  v_exp_f32 v119, v119
  v_add_f32 v112, 1.0, v112
  v_add_f32 v113, 1.0, v113
  v_add_f32 v114, 1.0, v114
  v_add_f32 v115, 1.0, v115
  v_add_f32 v116, 1.0, v116
  v_add_f32 v117, 1.0, v117
  v_add_f32 v118, 1.0, v118
  v_add_f32 v119, 1.0, v119
  v_rcp_f32 v112, v112
  v_rcp_f32 v113, v113
  v_rcp_f32 v114, v114
  v_rcp_f32 v115, v115
  v_rcp_f32 v116, v116
  v_rcp_f32 v117, v117
  v_rcp_f32 v118, v118
  v_rcp_f32 v119, v119
  v_mul_f32 v64, v64, v112
  v_mul_f32 v65, v65, v113
  v_mul_f32 v66, v66, v114
  v_mul_f32 v67, v67, v115
  v_mul_f32 v68, v68, v116
  v_mul_f32 v69, v69, v117
  v_mul_f32 v70, v70, v118
  v_mul_f32 v71, v71, v119
  v_cvt_pk_bf16_f32 v64, v64, v65
  v_cvt_pk_bf16_f32 v65, v66, v67
  v_cvt_pk_bf16_f32 v66, v68, v69
  v_cvt_pk_bf16_f32 v67, v70, v71
  buffer_store_dwordx4 v[64:67], v14, s[24:27], s36 offen offset:2048 sc1
  v_mul_f32 v120, v72, v72
  v_mul_f32 v121, v73, v73
  v_mul_f32 v122, v74, v74
  v_mul_f32 v123, v75, v75
  v_mul_f32 v124, v76, v76
  v_mul_f32 v125, v77, v77
  v_mul_f32 v126, v78, v78
  v_mul_f32 v127, v79, v79
  v_fma_f32 v120, v120, s61, v15
  v_fma_f32 v121, v121, s61, v15
  v_fma_f32 v122, v122, s61, v15
  v_fma_f32 v123, v123, s61, v15
  v_fma_f32 v124, v124, s61, v15
  v_fma_f32 v125, v125, s61, v15
  v_fma_f32 v126, v126, s61, v15
  v_fma_f32 v127, v127, s61, v15
  v_mul_f32 v120, v120, v72
  v_mul_f32 v121, v121, v73
  v_mul_f32 v122, v122, v74
  v_mul_f32 v123, v123, v75
  v_mul_f32 v124, v124, v76
  v_mul_f32 v125, v125, v77
  v_mul_f32 v126, v126, v78
  v_mul_f32 v127, v127, v79
  v_exp_f32 v120, v120
  v_exp_f32 v121, v121
  v_exp_f32 v122, v122
  v_exp_f32 v123, v123
  v_exp_f32 v124, v124
  v_exp_f32 v125, v125
  v_exp_f32 v126, v126
  v_exp_f32 v127, v127
  v_add_f32 v120, 1.0, v120
  v_add_f32 v121, 1.0, v121
  v_add_f32 v122, 1.0, v122
  v_add_f32 v123, 1.0, v123
  v_add_f32 v124, 1.0, v124
  v_add_f32 v125, 1.0, v125
  v_add_f32 v126, 1.0, v126
  v_add_f32 v127, 1.0, v127
  v_rcp_f32 v120, v120
  v_rcp_f32 v121, v121
  v_rcp_f32 v122, v122
  v_rcp_f32 v123, v123
  v_rcp_f32 v124, v124
  v_rcp_f32 v125, v125
  v_rcp_f32 v126, v126
  v_rcp_f32 v127, v127
  v_mul_f32 v72, v72, v120
  v_mul_f32 v73, v73, v121
  v_mul_f32 v74, v74, v122
  v_mul_f32 v75, v75, v123
  v_mul_f32 v76, v76, v124
  v_mul_f32 v77, v77, v125
  v_mul_f32 v78, v78, v126
  v_mul_f32 v79, v79, v127
  v_cvt_pk_bf16_f32 v72, v72, v73
  v_cvt_pk_bf16_f32 v73, v74, v75
  v_cvt_pk_bf16_f32 v74, v76, v77
  v_cvt_pk_bf16_f32 v75, v78, v79
  buffer_store_dwordx4 v[72:75], v14, s[24:27], s37 offen offset:2048 sc1
  v_mul_f32 v112, v80, v80
  v_mul_f32 v113, v81, v81
  v_mul_f32 v114, v82, v82
  v_mul_f32 v115, v83, v83
  v_mul_f32 v116, v84, v84
  v_mul_f32 v117, v85, v85
  v_mul_f32 v118, v86, v86
  v_mul_f32 v119, v87, v87
  v_fma_f32 v112, v112, s61, v15
  v_fma_f32 v113, v113, s61, v15
  v_fma_f32 v114, v114, s61, v15
  v_fma_f32 v115, v115, s61, v15
  v_fma_f32 v116, v116, s61, v15
  v_fma_f32 v117, v117, s61, v15
  v_fma_f32 v118, v118, s61, v15
  v_fma_f32 v119, v119, s61, v15
  v_mul_f32 v112, v112, v80
  v_mul_f32 v113, v113, v81
  v_mul_f32 v114, v114, v82
  v_mul_f32 v115, v115, v83
  v_mul_f32 v116, v116, v84
  v_mul_f32 v117, v117, v85
  v_mul_f32 v118, v118, v86
  v_mul_f32 v119, v119, v87
  v_exp_f32 v112, v112
  v_exp_f32 v113, v113
  v_exp_f32 v114, v114
  v_exp_f32 v115, v115
  v_exp_f32 v116, v116
  v_exp_f32 v117, v117
  v_exp_f32 v118, v118
  v_exp_f32 v119, v119
  v_add_f32 v112, 1.0, v112
  v_add_f32 v113, 1.0, v113
  v_add_f32 v114, 1.0, v114
  v_add_f32 v115, 1.0, v115
  v_add_f32 v116, 1.0, v116
  v_add_f32 v117, 1.0, v117
  v_add_f32 v118, 1.0, v118
  v_add_f32 v119, 1.0, v119
  v_rcp_f32 v112, v112
  v_rcp_f32 v113, v113
  v_rcp_f32 v114, v114
  v_rcp_f32 v115, v115
  v_rcp_f32 v116, v116
  v_rcp_f32 v117, v117
  v_rcp_f32 v118, v118
  v_rcp_f32 v119, v119
  v_mul_f32 v80, v80, v112
  v_mul_f32 v81, v81, v113
  v_mul_f32 v82, v82, v114
  v_mul_f32 v83, v83, v115
  v_mul_f32 v84, v84, v116
  v_mul_f32 v85, v85, v117
  v_mul_f32 v86, v86, v118
  v_mul_f32 v87, v87, v119
  v_cvt_pk_bf16_f32 v80, v80, v81
  v_cvt_pk_bf16_f32 v81, v82, v83
  v_cvt_pk_bf16_f32 v82, v84, v85
  v_cvt_pk_bf16_f32 v83, v86, v87
  buffer_store_dwordx4 v[80:83], v14, s[24:27], s38 offen offset:2048 sc1
  v_mul_f32 v120, v88, v88
  v_mul_f32 v121, v89, v89
  v_mul_f32 v122, v90, v90
  v_mul_f32 v123, v91, v91
  v_mul_f32 v124, v92, v92
  v_mul_f32 v125, v93, v93
  v_mul_f32 v126, v94, v94
  v_mul_f32 v127, v95, v95
  v_fma_f32 v120, v120, s61, v15
  v_fma_f32 v121, v121, s61, v15
  v_fma_f32 v122, v122, s61, v15
  v_fma_f32 v123, v123, s61, v15
  v_fma_f32 v124, v124, s61, v15
  v_fma_f32 v125, v125, s61, v15
  v_fma_f32 v126, v126, s61, v15
  v_fma_f32 v127, v127, s61, v15
  v_mul_f32 v120, v120, v88
  v_mul_f32 v121, v121, v89
  v_mul_f32 v122, v122, v90
  v_mul_f32 v123, v123, v91
  v_mul_f32 v124, v124, v92
  v_mul_f32 v125, v125, v93
  v_mul_f32 v126, v126, v94
  v_mul_f32 v127, v127, v95
  v_exp_f32 v120, v120
  v_exp_f32 v121, v121
  v_exp_f32 v122, v122
  v_exp_f32 v123, v123
  v_exp_f32 v124, v124
  v_exp_f32 v125, v125
  v_exp_f32 v126, v126
  v_exp_f32 v127, v127
  v_add_f32 v120, 1.0, v120
  v_add_f32 v121, 1.0, v121
  v_add_f32 v122, 1.0, v122
  v_add_f32 v123, 1.0, v123
  v_add_f32 v124, 1.0, v124
  v_add_f32 v125, 1.0, v125
  v_add_f32 v126, 1.0, v126
  v_add_f32 v127, 1.0, v127
  v_rcp_f32 v120, v120
  v_rcp_f32 v121, v121
  v_rcp_f32 v122, v122
  v_rcp_f32 v123, v123
  v_rcp_f32 v124, v124
  v_rcp_f32 v125, v125
  v_rcp_f32 v126, v126
  v_rcp_f32 v127, v127
  v_mul_f32 v88, v88, v120
  v_mul_f32 v89, v89, v121
  v_mul_f32 v90, v90, v122
  v_mul_f32 v91, v91, v123
  v_mul_f32 v92, v92, v124
  v_mul_f32 v93, v93, v125
  v_mul_f32 v94, v94, v126
  v_mul_f32 v95, v95, v127
  v_cvt_pk_bf16_f32 v88, v88, v89
  v_cvt_pk_bf16_f32 v89, v90, v91
  v_cvt_pk_bf16_f32 v90, v92, v93
  v_cvt_pk_bf16_f32 v91, v94, v95
  buffer_store_dwordx4 v[88:91], v14, s[24:27], s36 offen offset:3072 sc1
  v_mul_f32 v112, v96, v96
  v_mul_f32 v113, v97, v97
  v_mul_f32 v114, v98, v98
  v_mul_f32 v115, v99, v99
  v_mul_f32 v116, v100, v100
  v_mul_f32 v117, v101, v101
  v_mul_f32 v118, v102, v102
  v_mul_f32 v119, v103, v103
  v_fma_f32 v112, v112, s61, v15
  v_fma_f32 v113, v113, s61, v15
  v_fma_f32 v114, v114, s61, v15
  v_fma_f32 v115, v115, s61, v15
  v_fma_f32 v116, v116, s61, v15
  v_fma_f32 v117, v117, s61, v15
  v_fma_f32 v118, v118, s61, v15
  v_fma_f32 v119, v119, s61, v15
  v_mul_f32 v112, v112, v96
  v_mul_f32 v113, v113, v97
  v_mul_f32 v114, v114, v98
  v_mul_f32 v115, v115, v99
  v_mul_f32 v116, v116, v100
  v_mul_f32 v117, v117, v101
  v_mul_f32 v118, v118, v102
  v_mul_f32 v119, v119, v103
  v_exp_f32 v112, v112
  v_exp_f32 v113, v113
  v_exp_f32 v114, v114
  v_exp_f32 v115, v115
  v_exp_f32 v116, v116
  v_exp_f32 v117, v117
  v_exp_f32 v118, v118
  v_exp_f32 v119, v119
  v_add_f32 v112, 1.0, v112
  v_add_f32 v113, 1.0, v113
  v_add_f32 v114, 1.0, v114
  v_add_f32 v115, 1.0, v115
  v_add_f32 v116, 1.0, v116
  v_add_f32 v117, 1.0, v117
  v_add_f32 v118, 1.0, v118
  v_add_f32 v119, 1.0, v119
  v_rcp_f32 v112, v112
  v_rcp_f32 v113, v113
  v_rcp_f32 v114, v114
  v_rcp_f32 v115, v115
  v_rcp_f32 v116, v116
  v_rcp_f32 v117, v117
  v_rcp_f32 v118, v118
  v_rcp_f32 v119, v119
  v_mul_f32 v96, v96, v112
  v_mul_f32 v97, v97, v113
  v_mul_f32 v98, v98, v114
  v_mul_f32 v99, v99, v115
  v_mul_f32 v100, v100, v116
  v_mul_f32 v101, v101, v117
  v_mul_f32 v102, v102, v118
  v_mul_f32 v103, v103, v119
  v_cvt_pk_bf16_f32 v96, v96, v97
  v_cvt_pk_bf16_f32 v97, v98, v99
  v_cvt_pk_bf16_f32 v98, v100, v101
  v_cvt_pk_bf16_f32 v99, v102, v103
  buffer_store_dwordx4 v[96:99], v14, s[24:27], s37 offen offset:3072 sc1
  v_mul_f32 v120, v104, v104
  v_mul_f32 v121, v105, v105
  v_mul_f32 v122, v106, v106
  v_mul_f32 v123, v107, v107
  v_mul_f32 v124, v108, v108
  v_mul_f32 v125, v109, v109
  v_mul_f32 v126, v110, v110
  v_mul_f32 v127, v111, v111
  v_fma_f32 v120, v120, s61, v15
  v_fma_f32 v121, v121, s61, v15
  v_fma_f32 v122, v122, s61, v15
  v_fma_f32 v123, v123, s61, v15
  v_fma_f32 v124, v124, s61, v15
  v_fma_f32 v125, v125, s61, v15
  v_fma_f32 v126, v126, s61, v15
  v_fma_f32 v127, v127, s61, v15
  v_mul_f32 v120, v120, v104
  v_mul_f32 v121, v121, v105
  v_mul_f32 v122, v122, v106
  v_mul_f32 v123, v123, v107
  v_mul_f32 v124, v124, v108
  v_mul_f32 v125, v125, v109
  v_mul_f32 v126, v126, v110
  v_mul_f32 v127, v127, v111
  v_exp_f32 v120, v120
  v_exp_f32 v121, v121
  v_exp_f32 v122, v122
  v_exp_f32 v123, v123
  v_exp_f32 v124, v124
  v_exp_f32 v125, v125
  v_exp_f32 v126, v126
  v_exp_f32 v127, v127
  v_add_f32 v120, 1.0, v120
  v_add_f32 v121, 1.0, v121
  v_add_f32 v122, 1.0, v122
  v_add_f32 v123, 1.0, v123
  v_add_f32 v124, 1.0, v124
  v_add_f32 v125, 1.0, v125
  v_add_f32 v126, 1.0, v126
  v_add_f32 v127, 1.0, v127
  v_rcp_f32 v120, v120
  v_rcp_f32 v121, v121
  v_rcp_f32 v122, v122
  v_rcp_f32 v123, v123
  v_rcp_f32 v124, v124
  v_rcp_f32 v125, v125
  v_rcp_f32 v126, v126
  v_rcp_f32 v127, v127
  v_mul_f32 v104, v104, v120
  v_mul_f32 v105, v105, v121
  v_mul_f32 v106, v106, v122
  v_mul_f32 v107, v107, v123
  v_mul_f32 v108, v108, v124
  v_mul_f32 v109, v109, v125
  v_mul_f32 v110, v110, v126
  v_mul_f32 v111, v111, v127
  v_cvt_pk_bf16_f32 v104, v104, v105
  v_cvt_pk_bf16_f32 v105, v106, v107
  v_cvt_pk_bf16_f32 v106, v108, v109
  v_cvt_pk_bf16_f32 v107, v110, v111
  buffer_store_dwordx4 v[104:107], v14, s[24:27], s38 offen offset:3072 sc1
  s_waitcnt lgkmcnt(0)
  s_endpgm
K1_ML:
  s_setprio 3
  v_lshrrev_b32 v2, 3, v1
  v_lshrrev_b32 v3, 4, v1
  v_and_b32 v4, 7, v1
  s_lshl_b32 s60, s59, 5
  s_add_u32 s60, s60, s58
  s_mul_i32 s60, s60, 1280
  v_mul_u32_u24 v2, 2560, v2
  v_add_u32 v2, s60, v2
  v_xor_b32 v16, v3, v4
  v_lshl_add_u32 v16, v16, 4, v2
  v_or_b32 v17, 4, v3
  v_xor_b32 v17, v17, v4
  v_lshl_add_u32 v17, v17, 4, v2
  v_add_u32 v17, 20480, v17
  v_xor_b32 v18, v3, v4
  v_lshl_add_u32 v18, v18, 4, v2
  v_add_u32 v18, 1280, v18
  v_or_b32 v19, 4, v3
  v_xor_b32 v19, v19, v4
  v_lshl_add_u32 v19, v19, 4, v2
  v_add_u32 v19, 21760, v19
  s_mul_i32 s61, s55, 384
  s_mul_i32 s60, s59, 49152
  s_add_u32 s61, s61, s60
  v_add_u32 v2, 0, v1
  v_mul_u32_u24 v3, 2731, v2
  v_lshrrev_b32 v3, 16, v3
  v_mul_u32_u24 v4, 24, v3
  v_sub_u32 v4, v2, v4
  v_and_b32 v5, 6, v3
  v_xor_b32 v4, v4, v5
  v_and_b32 v6, 3, v3
  v_and_b32 v7, 4, v3
  v_lshl_or_b32 v6, v7, 1, v6
  v_mul_u32_u24 v6, 3072, v6
  v_lshl_add_u32 v6, v4, 4, v6
  v_add_u32 v10, s61, v6
  v_add_u32 v2, 64, v1
  v_mul_u32_u24 v3, 2731, v2
  v_lshrrev_b32 v3, 16, v3
  v_mul_u32_u24 v4, 24, v3
  v_sub_u32 v4, v2, v4
  v_and_b32 v5, 6, v3
  v_xor_b32 v4, v4, v5
  v_and_b32 v6, 3, v3
  v_and_b32 v7, 4, v3
  v_lshl_or_b32 v6, v7, 1, v6
  v_mul_u32_u24 v6, 3072, v6
  v_lshl_add_u32 v6, v4, 4, v6
  v_add_u32 v11, s61, v6
  v_add_u32 v2, 128, v1
  v_mul_u32_u24 v3, 2731, v2
  v_lshrrev_b32 v3, 16, v3
  v_mul_u32_u24 v4, 24, v3
  v_sub_u32 v4, v2, v4
  v_and_b32 v5, 6, v3
  v_xor_b32 v4, v4, v5
  v_and_b32 v6, 3, v3
  v_and_b32 v7, 4, v3
  v_lshl_or_b32 v6, v7, 1, v6
  v_mul_u32_u24 v6, 3072, v6
  v_lshl_add_u32 v6, v4, 4, v6
  v_add_u32 v12, s61, v6
  v_lshlrev_b32 v9, 4, v1
  s_waitcnt lgkmcnt(0)
  s_mov_b32 s24, s12
  s_and_b32 s25, s13, 0xffff
  s_mov_b32 s26, 1966080
  s_mov_b32 s27, 0x00020000
  s_mov_b32 s28, s4
  s_and_b32 s29, s5, 0xffff
  s_mov_b32 s30, 2621440
  s_mov_b32 s31, 0x00020000
  s_mov_b32 s32, s20
  s_and_b32 s33, s21, 0xffff
  s_mov_b32 s34, 1280
  s_mov_b32 s35, 0x00020000
  s_mul_i32 s45, s59, 6144
  s_lshl_b32 s46, s59, 12
  s_add_u32 s46, s46, 24576
  s_mov_b32 s41, 0
  s_mov_b32 s43, s42
  s_and_b32 s60, s59, 1
  s_lshl_b32 s60, s60, 10
  v_add_u32 v8, s60, v9
  v_min_u32 v8, 1264, v8
  s_add_u32 m0, s60, 122880
  s_nop 0
  buffer_load_dwordx4 v8, s[32:35], 0 offen lds
  s_mul_i32 s36, s42, 196608
  s_add_u32 s37, s36, 12288
  s_lshl_b32 s38, s42, 7
  s_add_u32 s49, s41, s46
  s_add_u32 m0, s49, 0
  s_nop 0
  buffer_load_dwordx4 v16, s[28:31], s38 offen lds
  s_add_u32 m0, s49, 1024
  s_nop 0
  buffer_load_dwordx4 v17, s[28:31], s38 offen lds
  s_add_u32 m0, s49, 2048
  s_nop 0
  buffer_load_dwordx4 v18, s[28:31], s38 offen lds
  s_add_u32 m0, s49, 3072
  s_nop 0
  buffer_load_dwordx4 v19, s[28:31], s38 offen lds
  s_add_u32 s49, s41, s45
  s_add_u32 m0, s49, 0
  s_nop 0
  buffer_load_dwordx4 v10, s[24:27], s36 offen lds
  s_add_u32 m0, s49, 1024
  s_nop 0
  buffer_load_dwordx4 v11, s[24:27], s36 offen lds
  s_add_u32 m0, s49, 2048
  s_nop 0
  buffer_load_dwordx4 v12, s[24:27], s36 offen lds
  s_add_u32 m0, s49, 3072
  s_nop 0
  buffer_load_dwordx4 v10, s[24:27], s37 offen lds
  s_add_u32 m0, s49, 4096
  s_nop 0
  buffer_load_dwordx4 v11, s[24:27], s37 offen lds
  s_add_u32 m0, s49, 5120
  s_nop 0
  buffer_load_dwordx4 v12, s[24:27], s37 offen lds
  s_add_u32 s42, s42, 1
  s_cmp_eq_u32 s42, 10
  s_cselect_b32 s42, 0, s42
  s_add_u32 s41, s41, 40960
  s_cmp_eq_u32 s41, 122880
  s_cselect_b32 s41, 0, s41
  s_mul_i32 s36, s42, 196608
  s_add_u32 s37, s36, 12288
  s_lshl_b32 s38, s42, 7
  s_add_u32 s49, s41, s46
  s_add_u32 m0, s49, 0
  s_nop 0
  buffer_load_dwordx4 v16, s[28:31], s38 offen lds
  s_add_u32 m0, s49, 1024
  s_nop 0
  buffer_load_dwordx4 v17, s[28:31], s38 offen lds
  s_add_u32 m0, s49, 2048
  s_nop 0
  buffer_load_dwordx4 v18, s[28:31], s38 offen lds
  s_add_u32 m0, s49, 3072
  s_nop 0
  buffer_load_dwordx4 v19, s[28:31], s38 offen lds
  s_add_u32 s49, s41, s45
  s_add_u32 m0, s49, 0
  s_nop 0
  buffer_load_dwordx4 v10, s[24:27], s36 offen lds
  s_add_u32 m0, s49, 1024
  s_nop 0
  buffer_load_dwordx4 v11, s[24:27], s36 offen lds
  s_add_u32 m0, s49, 2048
  s_nop 0
  buffer_load_dwordx4 v12, s[24:27], s36 offen lds
  s_add_u32 m0, s49, 3072
  s_nop 0
  buffer_load_dwordx4 v10, s[24:27], s37 offen lds
  s_add_u32 m0, s49, 4096
  s_nop 0
  buffer_load_dwordx4 v11, s[24:27], s37 offen lds
  s_add_u32 m0, s49, 5120
  s_nop 0
  buffer_load_dwordx4 v12, s[24:27], s37 offen lds
  s_add_u32 s42, s42, 1
  s_cmp_eq_u32 s42, 10
  s_cselect_b32 s42, 0, s42
  s_add_u32 s41, s41, 40960
  s_cmp_eq_u32 s41, 122880
  s_cselect_b32 s41, 0, s41
  v_and_b32 v2, 15, v1
  v_lshrrev_b32 v3, 1, v2
  v_lshrrev_b32 v22, 4, v1
  v_xor_b32 v22, v22, v3
  v_lshlrev_b32 v22, 4, v22
  v_lshl_add_u32 v22, v2, 7, v22
  s_lshl_b32 s60, s59, 12
  s_add_u32 s60, s60, 24576
  v_add_u32 v22, s60, v22
  v_xor_b32 v23, 64, v22
  s_and_b32 s60, s55, 1
  s_lshl_b32 s60, s60, 11
  v_add_u32 v22, s60, v22
  v_add_u32 v23, s60, v23
  v_lshrrev_b32 v20, 4, v1
  v_lshlrev_b32 v20, 4, v20
  v_add_u32 v20, 122880, v20
  v_mov_b32 v32, 0
  v_mov_b32 v33, 0
  v_mov_b32 v34, 0
  v_mov_b32 v35, 0
  v_mov_b32 v36, 0
  v_mov_b32 v37, 0
  v_mov_b32 v38, 0
  v_mov_b32 v39, 0
  s_mov_b32 s47, 0
  s_lshr_b32 s80, s55, 1
  s_lshl_b32 s60, s43, 7
  v_add_u32 v24, s60, v20
  v_add_u32 v25, s47, v22
  v_add_u32 v26, s47, v23
  v_add_u32 v2, 0, v1
  v_mul_u32_u24 v3, 6554, v2
  v_lshrrev_b32 v3, 16, v3
  v_mul_u32_u24 v4, 10, v3
  v_sub_u32 v4, v2, v4
  v_mul_u32_u24 v3, 1280, v3
  v_lshl_add_u32 v40, v4, 4, v3
  v_add_u32 v2, 64, v1
  v_mul_u32_u24 v3, 6554, v2
  v_lshrrev_b32 v3, 16, v3
  v_mul_u32_u24 v4, 10, v3
  v_sub_u32 v4, v2, v4
  v_mul_u32_u24 v3, 1280, v3
  v_lshl_add_u32 v41, v4, 4, v3
  v_add_u32 v2, 128, v1
  v_mul_u32_u24 v3, 6554, v2
  v_lshrrev_b32 v3, 16, v3
  v_mul_u32_u24 v4, 10, v3
  v_sub_u32 v4, v2, v4
  v_mul_u32_u24 v3, 1280, v3
  v_lshl_add_u32 v42, v4, 4, v3
  v_add_u32 v2, 192, v1
  v_mul_u32_u24 v3, 6554, v2
  v_lshrrev_b32 v3, 16, v3
  v_mul_u32_u24 v4, 10, v3
  v_sub_u32 v4, v2, v4
  v_mul_u32_u24 v3, 1280, v3
  v_lshl_add_u32 v43, v4, 4, v3
  v_add_u32 v2, 256, v1
  v_mul_u32_u24 v3, 6554, v2
  v_lshrrev_b32 v3, 16, v3
  v_mul_u32_u24 v4, 10, v3
  v_sub_u32 v4, v2, v4
  v_mul_u32_u24 v3, 1280, v3
  v_lshl_add_u32 v44, v4, 4, v3
  s_mul_i32 s44, s59, 5120
  s_add_u32 s44, s44, 124928
  v_lshrrev_b32 v2, 2, v1
  v_mul_u32_u24 v2, 160, v2
  v_add_u32 v2, s44, v2
  v_and_b32 v3, 3, v1
  v_lshl_add_u32 v45, v3, 4, v2
  v_lshl_add_u32 v46, v3, 3, v2
  s_lshl_b32 s62, s54, 3
  s_add_u32 s62, s62, s55
  s_add_u32 s72, s22, 9437184
  s_addc_u32 s73, s23, 0
  s_and_b32 s73, s73, 0xffff
  s_mov_b32 s74, 2785280
  s_mov_b32 s75, 0x00020000
  s_mov_b32 s48, 8
ML_LOOP:
  s_waitcnt vmcnt(10)
  s_barrier
  s_mul_i32 s36, s42, 196608
  s_add_u32 s37, s36, 12288
  s_lshl_b32 s38, s42, 7
  s_add_u32 s49, s41, s46
  s_add_u32 m0, s49, 0
  s_nop 0
  buffer_load_dwordx4 v16, s[28:31], s38 offen lds
  s_add_u32 m0, s49, 1024
  s_nop 0
  buffer_load_dwordx4 v17, s[28:31], s38 offen lds
  s_add_u32 m0, s49, 2048
  s_nop 0
  buffer_load_dwordx4 v18, s[28:31], s38 offen lds
  s_cmp_lg_u32 s80, s59
  s_cbranch_scc1 GSK_8
  ds_read_b128 a[0:3], v24 offset:0
  ds_read_b128 a[4:7], v25
  ds_read_b128 a[8:11], v24 offset:64
  ds_read_b128 a[12:15], v26
  s_add_u32 s47, s47, 40960
  s_cmp_eq_u32 s47, 122880
  s_cselect_b32 s47, 0, s47
  s_add_u32 s43, s43, 1
  s_cmp_eq_u32 s43, 10
  s_cselect_b32 s43, 0, s43
  s_lshl_b32 s60, s43, 7
  v_add_u32 v24, s60, v20
  v_add_u32 v25, s47, v22
  v_add_u32 v26, s47, v23
GSK_8:
  s_add_u32 m0, s49, 3072
  s_nop 0
  buffer_load_dwordx4 v19, s[28:31], s38 offen lds
  s_add_u32 s49, s41, s45
  s_add_u32 m0, s49, 0
  s_nop 0
  buffer_load_dwordx4 v10, s[24:27], s36 offen lds
  s_add_u32 m0, s49, 1024
  s_nop 0
  buffer_load_dwordx4 v11, s[24:27], s36 offen lds
  s_add_u32 m0, s49, 2048
  s_nop 0
  buffer_load_dwordx4 v12, s[24:27], s36 offen lds
  s_add_u32 m0, s49, 3072
  s_nop 0
  buffer_load_dwordx4 v10, s[24:27], s37 offen lds
  s_cmp_lg_u32 s80, s59
  s_cbranch_scc1 GSK_9
  s_waitcnt lgkmcnt(0)
  v_mfma_f32_16x16x32_bf16 v[32:35], a[0:3], a[4:7], v[32:35]
  v_mfma_f32_16x16x32_bf16 v[36:39], a[8:11], a[12:15], v[36:39]
GSK_9:
  s_add_u32 m0, s49, 4096
  s_nop 0
  buffer_load_dwordx4 v11, s[24:27], s37 offen lds
  s_add_u32 m0, s49, 5120
  s_nop 0
  buffer_load_dwordx4 v12, s[24:27], s37 offen lds
  s_add_u32 s42, s42, 1
  s_cmp_eq_u32 s42, 10
  s_cselect_b32 s42, 0, s42
  s_add_u32 s41, s41, 40960
  s_cmp_eq_u32 s41, 122880
  s_cselect_b32 s41, 0, s41
  s_sub_u32 s48, s48, 1
  s_cmp_lg_u32 s48, 0
  s_cbranch_scc1 ML_LOOP
  s_lshr_b32 s63, s62, 1
  s_and_b32 s64, s62, 1
  s_lshl_b32 s64, s64, 2
  s_add_u32 s64, s64, s59
  s_cmp_lt_u32 s63, 20
  s_cselect_b32 s68, s8, s16
  s_cselect_b32 s69, s9, s17
  s_mov_b32 s70, 1966080
  s_cselect_b32 s70, 819200, s70
  s_cselect_b32 s65, 0, 20
  s_and_b32 s69, s69, 0xffff
  s_mov_b32 s71, 0x00020000
  s_sub_u32 s65, s63, s65
  s_mul_i32 s65, s65, 40960
  s_mul_i32 s66, s64, 160
  s_add_u32 s65, s65, s66
  s_add_u32 m0, s44, 0
  s_nop 0
  buffer_load_dwordx4 v40, s[68:71], s65 offen lds
  s_add_u32 m0, s44, 1024
  s_nop 0
  buffer_load_dwordx4 v41, s[68:71], s65 offen lds
  s_add_u32 m0, s44, 2048
  s_nop 0
  buffer_load_dwordx4 v42, s[68:71], s65 offen lds
  s_add_u32 m0, s44, 3072
  s_nop 0
  buffer_load_dwordx4 v43, s[68:71], s65 offen lds
  s_add_u32 m0, s44, 4096
  s_nop 0
  buffer_load_dwordx4 v44, s[68:71], s65 offen lds
  s_mul_i32 s66, s64, 68
  s_add_u32 s66, s66, s63
  s_mul_i32 s66, s66, 5120
  s_add_u32 s67, s66, 4096
  s_add_u32 s92, s65, 1802240
  s_min_u32 s64, s63, 31
  s_bitcmp1_b32 0x21084, s64
  s_mov_b32 s65, 2560
  s_cselect_b32 s64, 640, 0
  s_cselect_b32 s65, 640, s65
  v_lshrrev_b32 v68, 4, v1
  v_mul_u32_u24 v68, s64, v68
  v_add_u32 v69, v46, v68
  v_add_u32 v68, v45, v68
  v_add_u32 v70, s65, v68
  v_add_u32 v71, s65, v69
  s_waitcnt vmcnt(15)
  s_barrier
  s_cmp_ge_u32 s62, 8
  s_cbranch_scc1 ML_NJ2
  s_mov_b32 s88, s16
  s_and_b32 s89, s17, 0xffff
  s_mov_b32 s90, 1966080
  s_mov_b32 s91, 0x00020000
  s_add_u32 s81, s41, s45
  s_add_u32 m0, s81, 0
  s_nop 0
  buffer_load_dwordx4 v40, s[88:91], s92 offen lds
  s_add_u32 m0, s81, 1024
  s_nop 0
  buffer_load_dwordx4 v41, s[88:91], s92 offen lds
  s_add_u32 m0, s81, 2048
  s_nop 0
  buffer_load_dwordx4 v42, s[88:91], s92 offen lds
  s_add_u32 m0, s81, 3072
  s_nop 0
  buffer_load_dwordx4 v43, s[88:91], s92 offen lds
  s_add_u32 m0, s81, 4096
  s_nop 0
  buffer_load_dwordx4 v44, s[88:91], s92 offen lds
  s_sub_u32 s81, s81, s44
  v_add_u32 v72, s81, v45
  v_add_u32 v73, s81, v46
  s_add_u32 s93, s66, 327680
  s_add_u32 s94, s93, 4096
ML_NJ2:
  s_sleep 2
  s_cmp_lg_u32 s80, s59
  s_cbranch_scc1 GSK_10
  ds_read_b128 a[0:3], v24 offset:0
  ds_read_b128 a[4:7], v25
  ds_read_b128 a[8:11], v24 offset:64
  ds_read_b128 a[12:15], v26
  s_add_u32 s47, s47, 40960
  s_cmp_eq_u32 s47, 122880
  s_cselect_b32 s47, 0, s47
  s_add_u32 s43, s43, 1
  s_cmp_eq_u32 s43, 10
  s_cselect_b32 s43, 0, s43
  s_lshl_b32 s60, s43, 7
  v_add_u32 v24, s60, v20
  v_add_u32 v25, s47, v22
  v_add_u32 v26, s47, v23
GSK_10:
  s_cmp_lg_u32 s80, s59
  s_cbranch_scc1 GSK_11
  s_waitcnt lgkmcnt(0)
  v_mfma_f32_16x16x32_bf16 v[32:35], a[0:3], a[4:7], v[32:35]
  v_mfma_f32_16x16x32_bf16 v[36:39], a[8:11], a[12:15], v[36:39]
GSK_11:
  s_waitcnt vmcnt(10)
  s_cmp_lt_u32 s62, 8
  s_cbranch_scc1 ML_NJ3
  s_waitcnt vmcnt(5)
ML_NJ3:
  s_barrier
  s_sleep 2
  s_cmp_lg_u32 s80, s59
  s_cbranch_scc1 GSK_12
  ds_read_b128 a[0:3], v24 offset:0
  ds_read_b128 a[4:7], v25
  ds_read_b128 a[8:11], v24 offset:64
  ds_read_b128 a[12:15], v26
  s_add_u32 s47, s47, 40960
  s_cmp_eq_u32 s47, 122880
  s_cselect_b32 s47, 0, s47
  s_add_u32 s43, s43, 1
  s_cmp_eq_u32 s43, 10
  s_cselect_b32 s43, 0, s43
  s_lshl_b32 s60, s43, 7
  v_add_u32 v24, s60, v20
  v_add_u32 v25, s47, v22
  v_add_u32 v26, s47, v23
GSK_12:
  s_cmp_lg_u32 s80, s59
  s_cbranch_scc1 GSK_13
  s_waitcnt lgkmcnt(0)
  v_mfma_f32_16x16x32_bf16 v[32:35], a[0:3], a[4:7], v[32:35]
  v_mfma_f32_16x16x32_bf16 v[36:39], a[8:11], a[12:15], v[36:39]
GSK_13:
  s_barrier
  s_waitcnt vmcnt(0)
  ds_read_b64_tr_b16 v[48:49], v68 offset:0
  ds_read_b64_tr_b16 v[50:51], v70 offset:0
  ds_read_b64_tr_b16 v[52:53], v68 offset:8
  ds_read_b64_tr_b16 v[54:55], v70 offset:8
  ds_read_b64_tr_b16 v[56:57], v68 offset:64
  ds_read_b64_tr_b16 v[58:59], v70 offset:64
  ds_read_b64_tr_b16 v[60:61], v68 offset:72
  ds_read_b64_tr_b16 v[62:63], v70 offset:72
  ds_read_b64_tr_b16 v[64:65], v69 offset:128
  ds_read_b64_tr_b16 v[66:67], v71 offset:128
  s_waitcnt lgkmcnt(0)
  buffer_store_dwordx4 v[48:51], v9, s[72:75], s66 offen offset:0 sc1
  buffer_store_dwordx4 v[52:55], v9, s[72:75], s66 offen offset:1024 sc1
  buffer_store_dwordx4 v[56:59], v9, s[72:75], s66 offen offset:2048 sc1
  buffer_store_dwordx4 v[60:63], v9, s[72:75], s66 offen offset:3072 sc1
  buffer_store_dwordx4 v[64:67], v9, s[72:75], s67 offen sc1
  s_cmp_lg_u32 s80, s59
  s_cbranch_scc1 ML_NOG_14
  s_add_u32 s76, s22, 12582912
  s_addc_u32 s77, s23, 0
  s_and_b32 s77, s77, 0xffff
  s_mov_b32 s78, 8192
  s_mov_b32 s79, 0x00020000
  s_lshl_b32 s60, s59, 5
  s_add_u32 s60, s60, s58
  s_and_b32 s61, s55, 1
  s_add_u32 s60, s60, s61
  s_lshl_b32 s60, s60, 2
  v_lshlrev_b32 v2, 3, v1
  s_nop 4
  v_add_f32 v32, v32, v36
  v_mul_f32 v32, 0xbfb8aa3b, v32
  v_exp_f32 v32, v32
  s_nop 0
  v_add_f32 v32, 1.0, v32
  v_rcp_f32 v32, v32
  s_mov_b64 exec, 0xffff
  s_nop 0
  buffer_store_dword v32, v2, s[76:79], s60 offen sc1
  s_mov_b64 exec, -1
ML_NOG_14:
  s_cmp_ge_u32 s62, 8
  s_cbranch_scc1 K1_EXIT
  ds_read_b64_tr_b16 v[76:77], v72 offset:0
  ds_read_b64_tr_b16 v[78:79], v72 offset:2560
  ds_read_b64_tr_b16 v[80:81], v72 offset:8
  ds_read_b64_tr_b16 v[82:83], v72 offset:2568
  ds_read_b64_tr_b16 v[84:85], v72 offset:64
  ds_read_b64_tr_b16 v[86:87], v72 offset:2624
  ds_read_b64_tr_b16 v[88:89], v72 offset:72
  ds_read_b64_tr_b16 v[90:91], v72 offset:2632
  ds_read_b64_tr_b16 v[92:93], v73 offset:128
  ds_read_b64_tr_b16 v[94:95], v73 offset:2688
  s_waitcnt lgkmcnt(0)
  buffer_store_dwordx4 v[76:79], v9, s[72:75], s93 offen offset:0 sc1
  buffer_store_dwordx4 v[80:83], v9, s[72:75], s93 offen offset:1024 sc1
  buffer_store_dwordx4 v[84:87], v9, s[72:75], s93 offen offset:2048 sc1
  buffer_store_dwordx4 v[88:91], v9, s[72:75], s93 offen offset:3072 sc1
  buffer_store_dwordx4 v[92:95], v9, s[72:75], s94 offen sc1
  s_endpgm
K1_EXIT:
  s_endpgm
.globl gm2_kernel
.p2align 8
.type gm2_kernel,@function
gm2_kernel:
  s_cmp_ge_u32 s2, 256
  s_cbranch_scc1 K2_EXIT
  s_load_dwordx2 s[4:5], s[0:1], 88
  s_load_dwordx2 s[6:7], s[0:1], 56
  s_load_dwordx2 s[8:9], s[0:1], 72
  v_and_b32 v1, 63, v0
  v_lshrrev_b32 v2, 6, v0
  s_and_b32 s50, s2, 7
  s_lshr_b32 s51, s2, 3
  v_readfirstlane_b32 s3, v2
  s_lshr_b32 s52, s50, 1
  s_lshl_b32 s52, s52, 3
  s_lshr_b32 s53, s51, 2
  s_add_u32 s52, s52, s53
  s_and_b32 s53, s50, 1
  s_lshl_b32 s53, s53, 2
  s_and_b32 s54, s51, 3
  s_add_u32 s53, s53, s54
  s_lshl_b32 s54, s3, 4
  s_add_u32 s54, s54, 4
  s_cmp_eq_u32 s3, 0
  s_cselect_b32 s54, 0, s54
  s_cselect_b32 s48, 4, 3
  s_mul_i32 s36, s52, 68
  s_add_u32 s36, s36, s54
  s_lshl_b32 s36, s36, 12
  s_mul_i32 s37, s53, 68
  s_add_u32 s37, s37, s54
  s_mul_i32 s37, s37, 5120
  v_lshlrev_b32 v2, 4, v1
  v_add_u32 v3, 4096, v2
  s_waitcnt lgkmcnt(0)
  s_mov_b32 s24, s4
  s_and_b32 s25, s5, 0xffff
  s_mov_b32 s26, 8912896
  s_mov_b32 s27, 0x00020000
  s_add_u32 s28, s4, 9437184
  s_addc_u32 s29, s5, 0
  s_and_b32 s29, s29, 0xffff
  s_mov_b32 s30, 2785280
  s_mov_b32 s31, 0x00020000
  buffer_load_dwordx4 a[0:3], v2, s[24:27], s36 offen offset:0
  buffer_load_dwordx4 a[16:19], v2, s[28:31], s37 offen offset:0
  buffer_load_dwordx4 a[4:7], v2, s[24:27], s36 offen offset:1024
  buffer_load_dwordx4 a[20:23], v2, s[28:31], s37 offen offset:1024
  buffer_load_dwordx4 a[8:11], v2, s[24:27], s36 offen offset:2048
  buffer_load_dwordx4 a[24:27], v2, s[28:31], s37 offen offset:2048
  buffer_load_dwordx4 a[12:15], v2, s[24:27], s36 offen offset:3072
  buffer_load_dwordx4 a[28:31], v2, s[28:31], s37 offen offset:3072
  buffer_load_dwordx4 a[32:35], v3, s[28:31], s37 offen offset:0
  s_add_u32 s36, s36, 4096
  s_add_u32 s37, s37, 5120
  buffer_load_dwordx4 a[36:39], v2, s[24:27], s36 offen offset:0
  buffer_load_dwordx4 a[52:55], v2, s[28:31], s37 offen offset:0
  buffer_load_dwordx4 a[40:43], v2, s[24:27], s36 offen offset:1024
  buffer_load_dwordx4 a[56:59], v2, s[28:31], s37 offen offset:1024
  buffer_load_dwordx4 a[44:47], v2, s[24:27], s36 offen offset:2048
  buffer_load_dwordx4 a[60:63], v2, s[28:31], s37 offen offset:2048
  buffer_load_dwordx4 a[48:51], v2, s[24:27], s36 offen offset:3072
  buffer_load_dwordx4 a[64:67], v2, s[28:31], s37 offen offset:3072
  buffer_load_dwordx4 a[68:71], v3, s[28:31], s37 offen offset:0
  s_add_u32 s36, s36, 4096
  s_add_u32 s37, s37, 5120
  buffer_load_dwordx4 a[72:75], v2, s[24:27], s36 offen offset:0
  buffer_load_dwordx4 a[88:91], v2, s[28:31], s37 offen offset:0
  buffer_load_dwordx4 a[76:79], v2, s[24:27], s36 offen offset:1024
  buffer_load_dwordx4 a[92:95], v2, s[28:31], s37 offen offset:1024
  buffer_load_dwordx4 a[80:83], v2, s[24:27], s36 offen offset:2048
  buffer_load_dwordx4 a[96:99], v2, s[28:31], s37 offen offset:2048
  buffer_load_dwordx4 a[84:87], v2, s[24:27], s36 offen offset:3072
  buffer_load_dwordx4 a[100:103], v2, s[28:31], s37 offen offset:3072
  buffer_load_dwordx4 a[104:107], v3, s[28:31], s37 offen offset:0
  s_add_u32 s36, s36, 4096
  s_add_u32 s37, s37, 5120
  s_mov_b32 s32, s6
  s_and_b32 s33, s7, 0xffff
  s_mov_b32 s34, 1280
  s_mov_b32 s35, 0x00020000
  s_add_u32 s40, s4, 12582912
  s_addc_u32 s41, s5, 0
  s_and_b32 s41, s41, 0xffff
  s_mov_b32 s42, 8192
  s_mov_b32 s43, 0x00020000
  s_mov_b32 s44, s8
  s_and_b32 s45, s9, 0xffff
  s_mov_b32 s46, 2621440
  s_mov_b32 s47, 0x00020000
  v_mov_b32 v8, 0
  v_mov_b32 v9, 0
  v_mov_b32 v10, 0
  v_mov_b32 v11, 0
  v_mov_b32 v12, 0
  v_mov_b32 v13, 0
  v_mov_b32 v14, 0
  v_mov_b32 v15, 0
  v_mov_b32 v16, 0
  v_mov_b32 v17, 0
  v_mov_b32 v18, 0
  v_mov_b32 v19, 0
  v_mov_b32 v20, 0
  v_mov_b32 v21, 0
  v_mov_b32 v22, 0
  v_mov_b32 v23, 0
  v_mov_b32 v24, 0
  v_mov_b32 v25, 0
  v_mov_b32 v26, 0
  v_mov_b32 v27, 0
  v_mov_b32 v28, 0
  v_mov_b32 v29, 0
  v_mov_b32 v30, 0
  v_mov_b32 v31, 0
  v_mov_b32 v32, 0
  v_mov_b32 v33, 0
  v_mov_b32 v34, 0
  v_mov_b32 v35, 0
  v_mov_b32 v36, 0
  v_mov_b32 v37, 0
  v_mov_b32 v38, 0
  v_mov_b32 v39, 0
  v_mov_b32 v40, 0
  v_mov_b32 v41, 0
  v_mov_b32 v42, 0
  v_mov_b32 v43, 0
  v_mov_b32 v44, 0
  v_mov_b32 v45, 0
  v_mov_b32 v46, 0
  v_mov_b32 v47, 0
  v_mov_b32 v48, 0
  v_mov_b32 v49, 0
  v_mov_b32 v50, 0
  v_mov_b32 v51, 0
  v_mov_b32 v52, 0
  v_mov_b32 v53, 0
  v_mov_b32 v54, 0
  v_mov_b32 v55, 0
  v_mov_b32 v56, 0
  v_mov_b32 v57, 0
  v_mov_b32 v58, 0
  v_mov_b32 v59, 0
  v_mov_b32 v60, 0
  v_mov_b32 v61, 0
  v_mov_b32 v62, 0
  v_mov_b32 v63, 0
  v_mov_b32 v64, 0
  v_mov_b32 v65, 0
  v_mov_b32 v66, 0
  v_mov_b32 v67, 0
  v_mov_b32 v68, 0
  v_mov_b32 v69, 0
  v_mov_b32 v70, 0
  v_mov_b32 v71, 0
  v_mov_b32 v72, 0
  v_mov_b32 v73, 0
  v_mov_b32 v74, 0
  v_mov_b32 v75, 0
  v_mov_b32 v76, 0
  v_mov_b32 v77, 0
  v_mov_b32 v78, 0
  v_mov_b32 v79, 0
  v_mov_b32 v80, 0
  v_mov_b32 v81, 0
  v_mov_b32 v82, 0
  v_mov_b32 v83, 0
  v_mov_b32 v84, 0
  v_mov_b32 v85, 0
  v_mov_b32 v86, 0
  v_mov_b32 v87, 0
K2_LOOP:
  s_waitcnt vmcnt(18)
  v_mfma_f32_16x16x32_bf16 v[8:11], a[16:19], a[0:3], v[8:11]
  v_mfma_f32_16x16x32_bf16 v[28:31], a[16:19], a[4:7], v[28:31]
  buffer_load_dwordx4 a[108:111], v2, s[24:27], s36 offen offset:0
  v_mfma_f32_16x16x32_bf16 v[48:51], a[16:19], a[8:11], v[48:51]
  v_mfma_f32_16x16x32_bf16 v[68:71], a[16:19], a[12:15], v[68:71]
  buffer_load_dwordx4 a[124:127], v2, s[28:31], s37 offen offset:0
  v_mfma_f32_16x16x32_bf16 v[12:15], a[20:23], a[0:3], v[12:15]
  v_mfma_f32_16x16x32_bf16 v[32:35], a[20:23], a[4:7], v[32:35]
  buffer_load_dwordx4 a[112:115], v2, s[24:27], s36 offen offset:1024
  v_mfma_f32_16x16x32_bf16 v[52:55], a[20:23], a[8:11], v[52:55]
  v_mfma_f32_16x16x32_bf16 v[72:75], a[20:23], a[12:15], v[72:75]
  buffer_load_dwordx4 a[128:131], v2, s[28:31], s37 offen offset:1024
  v_mfma_f32_16x16x32_bf16 v[16:19], a[24:27], a[0:3], v[16:19]
  v_mfma_f32_16x16x32_bf16 v[36:39], a[24:27], a[4:7], v[36:39]
  buffer_load_dwordx4 a[116:119], v2, s[24:27], s36 offen offset:2048
  v_mfma_f32_16x16x32_bf16 v[56:59], a[24:27], a[8:11], v[56:59]
  v_mfma_f32_16x16x32_bf16 v[76:79], a[24:27], a[12:15], v[76:79]
  buffer_load_dwordx4 a[132:135], v2, s[28:31], s37 offen offset:2048
  v_mfma_f32_16x16x32_bf16 v[20:23], a[28:31], a[0:3], v[20:23]
  v_mfma_f32_16x16x32_bf16 v[40:43], a[28:31], a[4:7], v[40:43]
  buffer_load_dwordx4 a[120:123], v2, s[24:27], s36 offen offset:3072
  v_mfma_f32_16x16x32_bf16 v[60:63], a[28:31], a[8:11], v[60:63]
  v_mfma_f32_16x16x32_bf16 v[80:83], a[28:31], a[12:15], v[80:83]
  buffer_load_dwordx4 a[136:139], v2, s[28:31], s37 offen offset:3072
  v_mfma_f32_16x16x32_bf16 v[24:27], a[32:35], a[0:3], v[24:27]
  v_mfma_f32_16x16x32_bf16 v[44:47], a[32:35], a[4:7], v[44:47]
  buffer_load_dwordx4 a[140:143], v3, s[28:31], s37 offen offset:0
  v_mfma_f32_16x16x32_bf16 v[64:67], a[32:35], a[8:11], v[64:67]
  v_mfma_f32_16x16x32_bf16 v[84:87], a[32:35], a[12:15], v[84:87]
  s_add_u32 s36, s36, 4096
  s_add_u32 s37, s37, 5120
  s_waitcnt vmcnt(18)
  v_mfma_f32_16x16x32_bf16 v[8:11], a[52:55], a[36:39], v[8:11]
  v_mfma_f32_16x16x32_bf16 v[28:31], a[52:55], a[40:43], v[28:31]
  buffer_load_dwordx4 a[0:3], v2, s[24:27], s36 offen offset:0
  v_mfma_f32_16x16x32_bf16 v[48:51], a[52:55], a[44:47], v[48:51]
  v_mfma_f32_16x16x32_bf16 v[68:71], a[52:55], a[48:51], v[68:71]
  buffer_load_dwordx4 a[16:19], v2, s[28:31], s37 offen offset:0
  v_mfma_f32_16x16x32_bf16 v[12:15], a[56:59], a[36:39], v[12:15]
  v_mfma_f32_16x16x32_bf16 v[32:35], a[56:59], a[40:43], v[32:35]
  buffer_load_dwordx4 a[4:7], v2, s[24:27], s36 offen offset:1024
  v_mfma_f32_16x16x32_bf16 v[52:55], a[56:59], a[44:47], v[52:55]
  v_mfma_f32_16x16x32_bf16 v[72:75], a[56:59], a[48:51], v[72:75]
  buffer_load_dwordx4 a[20:23], v2, s[28:31], s37 offen offset:1024
  v_mfma_f32_16x16x32_bf16 v[16:19], a[60:63], a[36:39], v[16:19]
  v_mfma_f32_16x16x32_bf16 v[36:39], a[60:63], a[40:43], v[36:39]
  buffer_load_dwordx4 a[8:11], v2, s[24:27], s36 offen offset:2048
  v_mfma_f32_16x16x32_bf16 v[56:59], a[60:63], a[44:47], v[56:59]
  v_mfma_f32_16x16x32_bf16 v[76:79], a[60:63], a[48:51], v[76:79]
  buffer_load_dwordx4 a[24:27], v2, s[28:31], s37 offen offset:2048
  v_mfma_f32_16x16x32_bf16 v[20:23], a[64:67], a[36:39], v[20:23]
  v_mfma_f32_16x16x32_bf16 v[40:43], a[64:67], a[40:43], v[40:43]
  buffer_load_dwordx4 a[12:15], v2, s[24:27], s36 offen offset:3072
  v_mfma_f32_16x16x32_bf16 v[60:63], a[64:67], a[44:47], v[60:63]
  v_mfma_f32_16x16x32_bf16 v[80:83], a[64:67], a[48:51], v[80:83]
  buffer_load_dwordx4 a[28:31], v2, s[28:31], s37 offen offset:3072
  v_mfma_f32_16x16x32_bf16 v[24:27], a[68:71], a[36:39], v[24:27]
  v_mfma_f32_16x16x32_bf16 v[44:47], a[68:71], a[40:43], v[44:47]
  buffer_load_dwordx4 a[32:35], v3, s[28:31], s37 offen offset:0
  v_mfma_f32_16x16x32_bf16 v[64:67], a[68:71], a[44:47], v[64:67]
  v_mfma_f32_16x16x32_bf16 v[84:87], a[68:71], a[48:51], v[84:87]
  s_add_u32 s36, s36, 4096
  s_add_u32 s37, s37, 5120
  s_waitcnt vmcnt(18)
  v_mfma_f32_16x16x32_bf16 v[8:11], a[88:91], a[72:75], v[8:11]
  v_mfma_f32_16x16x32_bf16 v[28:31], a[88:91], a[76:79], v[28:31]
  buffer_load_dwordx4 a[36:39], v2, s[24:27], s36 offen offset:0
  v_mfma_f32_16x16x32_bf16 v[48:51], a[88:91], a[80:83], v[48:51]
  v_mfma_f32_16x16x32_bf16 v[68:71], a[88:91], a[84:87], v[68:71]
  buffer_load_dwordx4 a[52:55], v2, s[28:31], s37 offen offset:0
  v_mfma_f32_16x16x32_bf16 v[12:15], a[92:95], a[72:75], v[12:15]
  v_mfma_f32_16x16x32_bf16 v[32:35], a[92:95], a[76:79], v[32:35]
  buffer_load_dwordx4 a[40:43], v2, s[24:27], s36 offen offset:1024
  v_mfma_f32_16x16x32_bf16 v[52:55], a[92:95], a[80:83], v[52:55]
  v_mfma_f32_16x16x32_bf16 v[72:75], a[92:95], a[84:87], v[72:75]
  buffer_load_dwordx4 a[56:59], v2, s[28:31], s37 offen offset:1024
  v_mfma_f32_16x16x32_bf16 v[16:19], a[96:99], a[72:75], v[16:19]
  v_mfma_f32_16x16x32_bf16 v[36:39], a[96:99], a[76:79], v[36:39]
  buffer_load_dwordx4 a[44:47], v2, s[24:27], s36 offen offset:2048
  v_mfma_f32_16x16x32_bf16 v[56:59], a[96:99], a[80:83], v[56:59]
  v_mfma_f32_16x16x32_bf16 v[76:79], a[96:99], a[84:87], v[76:79]
  buffer_load_dwordx4 a[60:63], v2, s[28:31], s37 offen offset:2048
  v_mfma_f32_16x16x32_bf16 v[20:23], a[100:103], a[72:75], v[20:23]
  v_mfma_f32_16x16x32_bf16 v[40:43], a[100:103], a[76:79], v[40:43]
  buffer_load_dwordx4 a[48:51], v2, s[24:27], s36 offen offset:3072
  v_mfma_f32_16x16x32_bf16 v[60:63], a[100:103], a[80:83], v[60:63]
  v_mfma_f32_16x16x32_bf16 v[80:83], a[100:103], a[84:87], v[80:83]
  buffer_load_dwordx4 a[64:67], v2, s[28:31], s37 offen offset:3072
  v_mfma_f32_16x16x32_bf16 v[24:27], a[104:107], a[72:75], v[24:27]
  v_mfma_f32_16x16x32_bf16 v[44:47], a[104:107], a[76:79], v[44:47]
  buffer_load_dwordx4 a[68:71], v3, s[28:31], s37 offen offset:0
  v_mfma_f32_16x16x32_bf16 v[64:67], a[104:107], a[80:83], v[64:67]
  v_mfma_f32_16x16x32_bf16 v[84:87], a[104:107], a[84:87], v[84:87]
  s_add_u32 s36, s36, 4096
  s_add_u32 s37, s37, 5120
  s_waitcnt vmcnt(18)
  v_mfma_f32_16x16x32_bf16 v[8:11], a[124:127], a[108:111], v[8:11]
  v_mfma_f32_16x16x32_bf16 v[28:31], a[124:127], a[112:115], v[28:31]
  buffer_load_dwordx4 a[72:75], v2, s[24:27], s36 offen offset:0
  v_mfma_f32_16x16x32_bf16 v[48:51], a[124:127], a[116:119], v[48:51]
  v_mfma_f32_16x16x32_bf16 v[68:71], a[124:127], a[120:123], v[68:71]
  buffer_load_dwordx4 a[88:91], v2, s[28:31], s37 offen offset:0
  v_mfma_f32_16x16x32_bf16 v[12:15], a[128:131], a[108:111], v[12:15]
  v_mfma_f32_16x16x32_bf16 v[32:35], a[128:131], a[112:115], v[32:35]
  buffer_load_dwordx4 a[76:79], v2, s[24:27], s36 offen offset:1024
  v_mfma_f32_16x16x32_bf16 v[52:55], a[128:131], a[116:119], v[52:55]
  v_mfma_f32_16x16x32_bf16 v[72:75], a[128:131], a[120:123], v[72:75]
  buffer_load_dwordx4 a[92:95], v2, s[28:31], s37 offen offset:1024
  v_mfma_f32_16x16x32_bf16 v[16:19], a[132:135], a[108:111], v[16:19]
  v_mfma_f32_16x16x32_bf16 v[36:39], a[132:135], a[112:115], v[36:39]
  buffer_load_dwordx4 a[80:83], v2, s[24:27], s36 offen offset:2048
  v_mfma_f32_16x16x32_bf16 v[56:59], a[132:135], a[116:119], v[56:59]
  v_mfma_f32_16x16x32_bf16 v[76:79], a[132:135], a[120:123], v[76:79]
  buffer_load_dwordx4 a[96:99], v2, s[28:31], s37 offen offset:2048
  v_mfma_f32_16x16x32_bf16 v[20:23], a[136:139], a[108:111], v[20:23]
  v_mfma_f32_16x16x32_bf16 v[40:43], a[136:139], a[112:115], v[40:43]
  buffer_load_dwordx4 a[84:87], v2, s[24:27], s36 offen offset:3072
  v_mfma_f32_16x16x32_bf16 v[60:63], a[136:139], a[116:119], v[60:63]
  v_mfma_f32_16x16x32_bf16 v[80:83], a[136:139], a[120:123], v[80:83]
  buffer_load_dwordx4 a[100:103], v2, s[28:31], s37 offen offset:3072
  v_mfma_f32_16x16x32_bf16 v[24:27], a[140:143], a[108:111], v[24:27]
  v_mfma_f32_16x16x32_bf16 v[44:47], a[140:143], a[112:115], v[44:47]
  buffer_load_dwordx4 a[104:107], v3, s[28:31], s37 offen offset:0
  v_mfma_f32_16x16x32_bf16 v[64:67], a[140:143], a[116:119], v[64:67]
  v_mfma_f32_16x16x32_bf16 v[84:87], a[140:143], a[120:123], v[84:87]
  s_add_u32 s36, s36, 4096
  s_add_u32 s37, s37, 5120
  s_sub_u32 s48, s48, 1
  s_cmp_lg_u32 s48, 0
  s_cbranch_scc1 K2_LOOP
  s_waitcnt vmcnt(18)
  v_mfma_f32_16x16x32_bf16 v[8:11], a[16:19], a[0:3], v[8:11]
  v_mfma_f32_16x16x32_bf16 v[28:31], a[16:19], a[4:7], v[28:31]
  buffer_load_dwordx4 a[108:111], v2, s[24:27], s36 offen offset:0
  v_mfma_f32_16x16x32_bf16 v[48:51], a[16:19], a[8:11], v[48:51]
  v_mfma_f32_16x16x32_bf16 v[68:71], a[16:19], a[12:15], v[68:71]
  buffer_load_dwordx4 a[124:127], v2, s[28:31], s37 offen offset:0
  v_mfma_f32_16x16x32_bf16 v[12:15], a[20:23], a[0:3], v[12:15]
  v_mfma_f32_16x16x32_bf16 v[32:35], a[20:23], a[4:7], v[32:35]
  buffer_load_dwordx4 a[112:115], v2, s[24:27], s36 offen offset:1024
  v_mfma_f32_16x16x32_bf16 v[52:55], a[20:23], a[8:11], v[52:55]
  v_mfma_f32_16x16x32_bf16 v[72:75], a[20:23], a[12:15], v[72:75]
  buffer_load_dwordx4 a[128:131], v2, s[28:31], s37 offen offset:1024
  v_mfma_f32_16x16x32_bf16 v[16:19], a[24:27], a[0:3], v[16:19]
  v_mfma_f32_16x16x32_bf16 v[36:39], a[24:27], a[4:7], v[36:39]
  buffer_load_dwordx4 a[116:119], v2, s[24:27], s36 offen offset:2048
  v_mfma_f32_16x16x32_bf16 v[56:59], a[24:27], a[8:11], v[56:59]
  v_mfma_f32_16x16x32_bf16 v[76:79], a[24:27], a[12:15], v[76:79]
  buffer_load_dwordx4 a[132:135], v2, s[28:31], s37 offen offset:2048
  v_mfma_f32_16x16x32_bf16 v[20:23], a[28:31], a[0:3], v[20:23]
  v_mfma_f32_16x16x32_bf16 v[40:43], a[28:31], a[4:7], v[40:43]
  buffer_load_dwordx4 a[120:123], v2, s[24:27], s36 offen offset:3072
  v_mfma_f32_16x16x32_bf16 v[60:63], a[28:31], a[8:11], v[60:63]
  v_mfma_f32_16x16x32_bf16 v[80:83], a[28:31], a[12:15], v[80:83]
  buffer_load_dwordx4 a[136:139], v2, s[28:31], s37 offen offset:3072
  v_mfma_f32_16x16x32_bf16 v[24:27], a[32:35], a[0:3], v[24:27]
  v_mfma_f32_16x16x32_bf16 v[44:47], a[32:35], a[4:7], v[44:47]
  buffer_load_dwordx4 a[140:143], v3, s[28:31], s37 offen offset:0
  v_mfma_f32_16x16x32_bf16 v[64:67], a[32:35], a[8:11], v[64:67]
  v_mfma_f32_16x16x32_bf16 v[84:87], a[32:35], a[12:15], v[84:87]
  s_add_u32 s36, s36, 4096
  s_add_u32 s37, s37, 5120
  v_and_b32 v4, 15, v1
  v_lshrrev_b32 v5, 4, v1
  s_lshl_b32 s55, s52, 6
  s_lshr_b32 s56, s3, 1
  s_lshl_b32 s56, s56, 5
  s_add_u32 s55, s55, s56
  s_and_b32 s56, s3, 1
  s_add_u32 s55, s55, s56
  v_lshlrev_b32 v6, 3, v4
  s_lshl_b32 s56, s55, 2
  buffer_load_dword v88, v6, s[40:43], s56 offen
  v_lshlrev_b32 v6, 4, v5
  v_lshlrev_b32 v7, 3, v5
  s_mul_i32 s57, s53, 160
  buffer_load_dwordx4 v[92:95], v6, s[32:35], s57 offen
  buffer_load_dwordx4 v[96:99], v6, s[32:35], s57 offen offset:64
  buffer_load_dwordx2 v[100:101], v7, s[32:35], s57 offen offset:128
  s_waitcnt vmcnt(22)
  v_mfma_f32_16x16x32_bf16 v[8:11], a[52:55], a[36:39], v[8:11]
  v_mfma_f32_16x16x32_bf16 v[28:31], a[52:55], a[40:43], v[28:31]
  v_mfma_f32_16x16x32_bf16 v[48:51], a[52:55], a[44:47], v[48:51]
  v_mfma_f32_16x16x32_bf16 v[68:71], a[52:55], a[48:51], v[68:71]
  v_mfma_f32_16x16x32_bf16 v[12:15], a[56:59], a[36:39], v[12:15]
  v_mfma_f32_16x16x32_bf16 v[32:35], a[56:59], a[40:43], v[32:35]
  v_mfma_f32_16x16x32_bf16 v[52:55], a[56:59], a[44:47], v[52:55]
  v_mfma_f32_16x16x32_bf16 v[72:75], a[56:59], a[48:51], v[72:75]
  v_mfma_f32_16x16x32_bf16 v[16:19], a[60:63], a[36:39], v[16:19]
  v_mfma_f32_16x16x32_bf16 v[36:39], a[60:63], a[40:43], v[36:39]
  v_mfma_f32_16x16x32_bf16 v[56:59], a[60:63], a[44:47], v[56:59]
  v_mfma_f32_16x16x32_bf16 v[76:79], a[60:63], a[48:51], v[76:79]
  v_mfma_f32_16x16x32_bf16 v[20:23], a[64:67], a[36:39], v[20:23]
  v_mfma_f32_16x16x32_bf16 v[40:43], a[64:67], a[40:43], v[40:43]
  v_mfma_f32_16x16x32_bf16 v[60:63], a[64:67], a[44:47], v[60:63]
  v_mfma_f32_16x16x32_bf16 v[80:83], a[64:67], a[48:51], v[80:83]
  v_mfma_f32_16x16x32_bf16 v[24:27], a[68:71], a[36:39], v[24:27]
  v_mfma_f32_16x16x32_bf16 v[44:47], a[68:71], a[40:43], v[44:47]
  v_mfma_f32_16x16x32_bf16 v[64:67], a[68:71], a[44:47], v[64:67]
  v_mfma_f32_16x16x32_bf16 v[84:87], a[68:71], a[48:51], v[84:87]
  s_waitcnt vmcnt(13)
  v_mfma_f32_16x16x32_bf16 v[8:11], a[88:91], a[72:75], v[8:11]
  v_mfma_f32_16x16x32_bf16 v[28:31], a[88:91], a[76:79], v[28:31]
  v_mfma_f32_16x16x32_bf16 v[48:51], a[88:91], a[80:83], v[48:51]
  v_mfma_f32_16x16x32_bf16 v[68:71], a[88:91], a[84:87], v[68:71]
  v_mfma_f32_16x16x32_bf16 v[12:15], a[92:95], a[72:75], v[12:15]
  v_mfma_f32_16x16x32_bf16 v[32:35], a[92:95], a[76:79], v[32:35]
  v_mfma_f32_16x16x32_bf16 v[52:55], a[92:95], a[80:83], v[52:55]
  v_mfma_f32_16x16x32_bf16 v[72:75], a[92:95], a[84:87], v[72:75]
  v_mfma_f32_16x16x32_bf16 v[16:19], a[96:99], a[72:75], v[16:19]
  v_mfma_f32_16x16x32_bf16 v[36:39], a[96:99], a[76:79], v[36:39]
  v_mfma_f32_16x16x32_bf16 v[56:59], a[96:99], a[80:83], v[56:59]
  v_mfma_f32_16x16x32_bf16 v[76:79], a[96:99], a[84:87], v[76:79]
  v_mfma_f32_16x16x32_bf16 v[20:23], a[100:103], a[72:75], v[20:23]
  v_mfma_f32_16x16x32_bf16 v[40:43], a[100:103], a[76:79], v[40:43]
  v_mfma_f32_16x16x32_bf16 v[60:63], a[100:103], a[80:83], v[60:63]
  v_mfma_f32_16x16x32_bf16 v[80:83], a[100:103], a[84:87], v[80:83]
  v_mfma_f32_16x16x32_bf16 v[24:27], a[104:107], a[72:75], v[24:27]
  v_mfma_f32_16x16x32_bf16 v[44:47], a[104:107], a[76:79], v[44:47]
  v_mfma_f32_16x16x32_bf16 v[64:67], a[104:107], a[80:83], v[64:67]
  v_mfma_f32_16x16x32_bf16 v[84:87], a[104:107], a[84:87], v[84:87]
  s_waitcnt vmcnt(4)
  v_mfma_f32_16x16x32_bf16 v[8:11], a[124:127], a[108:111], v[8:11]
  v_mfma_f32_16x16x32_bf16 v[28:31], a[124:127], a[112:115], v[28:31]
  v_mfma_f32_16x16x32_bf16 v[48:51], a[124:127], a[116:119], v[48:51]
  v_mfma_f32_16x16x32_bf16 v[68:71], a[124:127], a[120:123], v[68:71]
  v_mfma_f32_16x16x32_bf16 v[12:15], a[128:131], a[108:111], v[12:15]
  v_mfma_f32_16x16x32_bf16 v[32:35], a[128:131], a[112:115], v[32:35]
  v_mfma_f32_16x16x32_bf16 v[52:55], a[128:131], a[116:119], v[52:55]
  v_mfma_f32_16x16x32_bf16 v[72:75], a[128:131], a[120:123], v[72:75]
  v_mfma_f32_16x16x32_bf16 v[16:19], a[132:135], a[108:111], v[16:19]
  v_mfma_f32_16x16x32_bf16 v[36:39], a[132:135], a[112:115], v[36:39]
  v_mfma_f32_16x16x32_bf16 v[56:59], a[132:135], a[116:119], v[56:59]
  v_mfma_f32_16x16x32_bf16 v[76:79], a[132:135], a[120:123], v[76:79]
  v_mfma_f32_16x16x32_bf16 v[20:23], a[136:139], a[108:111], v[20:23]
  v_mfma_f32_16x16x32_bf16 v[40:43], a[136:139], a[112:115], v[40:43]
  v_mfma_f32_16x16x32_bf16 v[60:63], a[136:139], a[116:119], v[60:63]
  v_mfma_f32_16x16x32_bf16 v[80:83], a[136:139], a[120:123], v[80:83]
  v_mfma_f32_16x16x32_bf16 v[24:27], a[140:143], a[108:111], v[24:27]
  v_mfma_f32_16x16x32_bf16 v[44:47], a[140:143], a[112:115], v[44:47]
  v_mfma_f32_16x16x32_bf16 v[64:67], a[140:143], a[116:119], v[64:67]
  v_mfma_f32_16x16x32_bf16 v[84:87], a[140:143], a[120:123], v[84:87]
  v_mul_u32_u24 v4, 2560, v4
  v_add_u32 v6, v4, v6
  v_add_u32 v7, v4, v7
  s_mul_i32 s56, s55, 1280
  s_add_u32 s56, s56, s57
  s_mul_i32 s58, s3, 20480
  v_add_u32 v4, s58, v2
  s_mul_i32 s58, s3, 5120
  v_add_u32 v5, s58, v2
  s_nop 4
  ds_write_b128 v4, v[8:11] offset:0
  ds_write_b128 v4, v[12:15] offset:1024
  ds_write_b128 v4, v[16:19] offset:2048
  ds_write_b128 v4, v[20:23] offset:3072
  ds_write_b128 v4, v[24:27] offset:4096
  ds_write_b128 v4, v[28:31] offset:5120
  ds_write_b128 v4, v[32:35] offset:6144
  ds_write_b128 v4, v[36:39] offset:7168
  ds_write_b128 v4, v[40:43] offset:8192
  ds_write_b128 v4, v[44:47] offset:9216
  ds_write_b128 v4, v[48:51] offset:10240
  ds_write_b128 v4, v[52:55] offset:11264
  ds_write_b128 v4, v[56:59] offset:12288
  ds_write_b128 v4, v[60:63] offset:13312
  ds_write_b128 v4, v[64:67] offset:14336
  ds_write_b128 v4, v[68:71] offset:15360
  ds_write_b128 v4, v[72:75] offset:16384
  ds_write_b128 v4, v[76:79] offset:17408
  ds_write_b128 v4, v[80:83] offset:18432
  ds_write_b128 v4, v[84:87] offset:19456
  s_waitcnt lgkmcnt(0)
  s_barrier
  ds_read_b128 v[8:11], v5 offset:0
  ds_read_b128 v[12:15], v5 offset:1024
  ds_read_b128 v[16:19], v5 offset:2048
  ds_read_b128 v[20:23], v5 offset:3072
  ds_read_b128 v[24:27], v5 offset:4096
  ds_read_b128 v[28:31], v5 offset:20480
  ds_read_b128 v[32:35], v5 offset:21504
  ds_read_b128 v[36:39], v5 offset:22528
  ds_read_b128 v[40:43], v5 offset:23552
  ds_read_b128 v[44:47], v5 offset:24576
  ds_read_b128 v[48:51], v5 offset:40960
  ds_read_b128 v[52:55], v5 offset:41984
  ds_read_b128 v[56:59], v5 offset:43008
  ds_read_b128 v[60:63], v5 offset:44032
  ds_read_b128 v[64:67], v5 offset:45056
  v_add_u32 v5, 61440, v5
  s_waitcnt vmcnt(0)
  v_lshlrev_b32 v104, 16, v92
  v_and_b32 v105, 0xffff0000, v92
  v_lshlrev_b32 v106, 16, v93
  v_and_b32 v107, 0xffff0000, v93
  v_lshlrev_b32 v108, 16, v94
  v_and_b32 v109, 0xffff0000, v94
  v_lshlrev_b32 v110, 16, v95
  v_and_b32 v111, 0xffff0000, v95
  v_lshlrev_b32 v112, 16, v96
  v_and_b32 v113, 0xffff0000, v96
  v_lshlrev_b32 v114, 16, v97
  v_and_b32 v115, 0xffff0000, v97
  v_lshlrev_b32 v116, 16, v98
  v_and_b32 v117, 0xffff0000, v98
  v_lshlrev_b32 v118, 16, v99
  v_and_b32 v119, 0xffff0000, v99
  v_lshlrev_b32 v120, 16, v100
  v_and_b32 v121, 0xffff0000, v100
  v_lshlrev_b32 v122, 16, v101
  v_and_b32 v123, 0xffff0000, v101
  s_waitcnt lgkmcnt(5)
  ds_read_b128 v[68:71], v5 offset:0
  ds_read_b128 v[72:75], v5 offset:1024
  ds_read_b128 v[76:79], v5 offset:2048
  ds_read_b128 v[80:83], v5 offset:3072
  ds_read_b128 v[84:87], v5 offset:4096
  v_sub_f32 v89, 1.0, v88
  v_add_f32 v104, v104, v28
  v_add_f32 v105, v105, v29
  v_add_f32 v106, v106, v30
  v_add_f32 v107, v107, v31
  v_add_f32 v108, v108, v32
  v_add_f32 v109, v109, v33
  v_add_f32 v110, v110, v34
  v_add_f32 v111, v111, v35
  v_add_f32 v112, v112, v36
  v_add_f32 v113, v113, v37
  v_add_f32 v114, v114, v38
  v_add_f32 v115, v115, v39
  v_add_f32 v116, v116, v40
  v_add_f32 v117, v117, v41
  v_add_f32 v118, v118, v42
  v_add_f32 v119, v119, v43
  v_add_f32 v120, v120, v44
  v_add_f32 v121, v121, v45
  v_add_f32 v122, v122, v46
  v_add_f32 v123, v123, v47
  s_waitcnt lgkmcnt(5)
  v_add_f32 v104, v104, v48
  v_add_f32 v105, v105, v49
  v_add_f32 v106, v106, v50
  v_add_f32 v107, v107, v51
  v_add_f32 v108, v108, v52
  v_add_f32 v109, v109, v53
  v_add_f32 v110, v110, v54
  v_add_f32 v111, v111, v55
  v_add_f32 v112, v112, v56
  v_add_f32 v113, v113, v57
  v_add_f32 v114, v114, v58
  v_add_f32 v115, v115, v59
  v_add_f32 v116, v116, v60
  v_add_f32 v117, v117, v61
  v_add_f32 v118, v118, v62
  v_add_f32 v119, v119, v63
  v_add_f32 v120, v120, v64
  v_add_f32 v121, v121, v65
  v_add_f32 v122, v122, v66
  v_add_f32 v123, v123, v67
  v_mul_f32 v8, v88, v8
  v_mul_f32 v9, v88, v9
  v_mul_f32 v10, v88, v10
  v_mul_f32 v11, v88, v11
  v_mul_f32 v12, v88, v12
  v_mul_f32 v13, v88, v13
  v_mul_f32 v14, v88, v14
  v_mul_f32 v15, v88, v15
  v_mul_f32 v16, v88, v16
  v_mul_f32 v17, v88, v17
  v_mul_f32 v18, v88, v18
  v_mul_f32 v19, v88, v19
  v_mul_f32 v20, v88, v20
  v_mul_f32 v21, v88, v21
  v_mul_f32 v22, v88, v22
  v_mul_f32 v23, v88, v23
  v_mul_f32 v24, v88, v24
  v_mul_f32 v25, v88, v25
  v_mul_f32 v26, v88, v26
  v_mul_f32 v27, v88, v27
  s_waitcnt lgkmcnt(0)
  v_add_f32 v104, v104, v68
  v_add_f32 v105, v105, v69
  v_add_f32 v106, v106, v70
  v_add_f32 v107, v107, v71
  v_add_f32 v108, v108, v72
  v_add_f32 v109, v109, v73
  v_add_f32 v110, v110, v74
  v_add_f32 v111, v111, v75
  v_add_f32 v112, v112, v76
  v_add_f32 v113, v113, v77
  v_add_f32 v114, v114, v78
  v_add_f32 v115, v115, v79
  v_add_f32 v116, v116, v80
  v_add_f32 v117, v117, v81
  v_add_f32 v118, v118, v82
  v_add_f32 v119, v119, v83
  v_add_f32 v120, v120, v84
  v_add_f32 v121, v121, v85
  v_add_f32 v122, v122, v86
  v_add_f32 v123, v123, v87
  v_fma_f32 v104, v89, v104, v8
  v_fma_f32 v105, v89, v105, v9
  v_fma_f32 v106, v89, v106, v10
  v_fma_f32 v107, v89, v107, v11
  v_fma_f32 v108, v89, v108, v12
  v_fma_f32 v109, v89, v109, v13
  v_fma_f32 v110, v89, v110, v14
  v_fma_f32 v111, v89, v111, v15
  v_fma_f32 v112, v89, v112, v16
  v_fma_f32 v113, v89, v113, v17
  v_fma_f32 v114, v89, v114, v18
  v_fma_f32 v115, v89, v115, v19
  v_fma_f32 v116, v89, v116, v20
  v_fma_f32 v117, v89, v117, v21
  v_fma_f32 v118, v89, v118, v22
  v_fma_f32 v119, v89, v119, v23
  v_fma_f32 v120, v89, v120, v24
  v_fma_f32 v121, v89, v121, v25
  v_fma_f32 v122, v89, v122, v26
  v_fma_f32 v123, v89, v123, v27
  v_cvt_pk_bf16_f32 v8, v104, v105
  v_cvt_pk_bf16_f32 v9, v106, v107
  v_cvt_pk_bf16_f32 v10, v108, v109
  v_cvt_pk_bf16_f32 v11, v110, v111
  v_cvt_pk_bf16_f32 v12, v112, v113
  v_cvt_pk_bf16_f32 v13, v114, v115
  v_cvt_pk_bf16_f32 v14, v116, v117
  v_cvt_pk_bf16_f32 v15, v118, v119
  v_cvt_pk_bf16_f32 v16, v120, v121
  v_cvt_pk_bf16_f32 v17, v122, v123
  buffer_store_dwordx4 v[8:11], v6, s[44:47], s56 offen
  buffer_store_dwordx4 v[12:15], v6, s[44:47], s56 offen offset:64
  buffer_store_dwordx2 v[16:17], v7, s[44:47], s56 offen offset:128
K2_EXIT:
  s_endpgm
CODE_END:
.section .rodata,"a"
.p2align 6
.amdhsa_kernel gm1_kernel
  .amdhsa_next_free_vgpr 256
  .amdhsa_next_free_sgpr 102
  .amdhsa_accum_offset 208
  .amdhsa_group_segment_fixed_size 0
  .amdhsa_kernarg_size 96
  .amdhsa_user_sgpr_count 2
  .amdhsa_user_sgpr_kernarg_segment_ptr 1
  .amdhsa_system_sgpr_workgroup_id_x 1
.end_amdhsa_kernel
.p2align 6
.amdhsa_kernel gm2_kernel
  .amdhsa_next_free_vgpr 272
  .amdhsa_next_free_sgpr 102
  .amdhsa_accum_offset 128
  .amdhsa_group_segment_fixed_size 0
  .amdhsa_kernarg_size 96
  .amdhsa_user_sgpr_count 2
  .amdhsa_user_sgpr_kernarg_segment_ptr 1
  .amdhsa_system_sgpr_workgroup_id_x 1
.end_amdhsa_kernel
```
